```python
import torch

def _softmax(x, axis=-1):
    return torch.softmax(x, dim=axis)
def _gelu(x):
    return torch.nn.functional.gelu(x, approximate="tanh")
def _silu(x):
    return torch.nn.functional.silu(x)
def _sigmoid(x):
    return torch.sigmoid(x)
def _layernorm(x, axis=-1, eps=1e-5):
    m = x.mean(dim=axis, keepdim=True)
    v = x.var(dim=axis, keepdim=True, unbiased=False)
    return (x - m) / torch.sqrt(v + eps)
def _scatter_add(tgt, idx, src, axis=0):
    return tgt.clone().index_add_(axis, idx, src)
def _segment_sum(src, seg, n):
    out = torch.zeros((n,) + src.shape[1:], dtype=src.dtype)
    return out.index_add_(0, seg, src)
def _pad(x, pw):
    flat = tuple(v for pair in reversed(pw) for v in pair)
    return torch.nn.functional.pad(x, flat)

kernel_name = 'concat_heads__spectral_fnet__softmax_full_mha__prompt'

def setup_inputs():

    _w = (lambda a: (lambda t: t.to(torch.bfloat16) if t.is_floating_point() else t)(torch.as_tensor(a)))
    def _A_setup():
        B, S, D = 1, 2048, 512
        ns = torch.arange(S)[:, None] * torch.arange(S)[None, :]
        nd = torch.arange(D)[:, None] * torch.arange(D)[None, :]
        Ws_re = torch.cos(-2.0 * torch.pi * ns / S).to(float)
        Ws_im = torch.sin(-2.0 * torch.pi * ns / S).to(float)
        Wd_re = torch.cos(-2.0 * torch.pi * nd / D).to(float)
        Wd_im = torch.sin(-2.0 * torch.pi * nd / D).to(float)
        return {
            "x": _w((lambda *s: torch.randn(*s, dtype=torch.bfloat16) * 0.05)(B, S, D)),
            "dft_seq_re": _w(Ws_re),
            "dft_seq_im": _w(Ws_im),
            "dft_hid_re": _w(Wd_re),
            "dft_hid_im": _w(Wd_im),
        }
    _A_in = _A_setup()

    def _B_setup():
        B, S, D = 1, 2048, 512
        return {
            "x": _w((lambda *s: torch.randn(*s, dtype=torch.bfloat16) * 0.2)(B, S, D)),
            "wqkv": _w((lambda *s: torch.randn(*s, dtype=torch.bfloat16) * 0.8)(D, 3 * D)),
            "wo": _w((lambda *s: torch.randn(*s, dtype=torch.bfloat16) * 0.2)(D, D)),
        }
    _B_in = _B_setup()

    return {
        "A_x": _A_in["x"],
        "A_dft_seq_re": _A_in["dft_seq_re"],
        "A_dft_seq_im": _A_in["dft_seq_im"],
        "A_dft_hid_re": _A_in["dft_hid_re"],
        "A_dft_hid_im": _A_in["dft_hid_im"],
        "B_x": _B_in["x"],
        "B_wqkv": _B_in["wqkv"],
        "B_wo": _B_in["wo"],
    }

def reference(A_x, A_dft_seq_re, A_dft_seq_im, A_dft_hid_re, A_dft_hid_im, B_x, B_wqkv, B_wo):
    def _A_ref(x, dft_seq_re, dft_seq_im, dft_hid_re, dft_hid_im):
        a = torch.einsum("bsd,ed->bse", x, dft_hid_re)
        b = torch.einsum("bsd,ed->bse", x, dft_hid_im)
        y = torch.einsum("ts,bse->bte", dft_seq_re, a) - torch.einsum("ts,bse->bte", dft_seq_im, b)
        return y

    def _B_ref(x, wqkv, wo):
        B, S, D = x.shape
        H = 32; Dh = D // H
        qkv = (lambda x, *d: x.permute(*d))((x @ wqkv).reshape(B, S, 3, H, Dh), 2, 0, 3, 1, 4)
        q, k, v = qkv[0], qkv[1], qkv[2]
        scale = Dh ** -0.5
        scores = torch.einsum("bhqd,bhkd->bhqk", q, k) * scale
        p = _softmax(scores, axis=-1)
        o = torch.einsum("bhqk,bhkd->bhqd", p, v)
        return (lambda x, *d: x.permute(*d))(o, 0, 2, 1, 3).reshape(B, S, D) @ wo

    a = _A_ref(A_x, A_dft_seq_re, A_dft_seq_im, A_dft_hid_re, A_dft_hid_im)
    b = _B_ref(B_x, B_wqkv, B_wo)
    return torch.concatenate([a, b], axis=-1)
```

```asm
; @launch grid=(256,1,1) block=(512,1,1) lds=157760
.amdgcn_target "amdgcn-amd-amdhsa--gfx950"
.text
.globl concat_heads__spectral_fnet__softmax_full_mha__prompt_kernel
.p2align 8
.type concat_heads__spectral_fnet__softmax_full_mha__prompt_kernel,@function
concat_heads__spectral_fnet__softmax_full_mha__prompt_kernel:
    s_cmp_ge_u32 s2, 256
    s_cbranch_scc1 F_end
    s_and_b32 s5, s2, 1
    s_lshl_b32 s5, s5, 3
    s_add_u32 s5, s5, 24
    s_cmp_ge_u32 s2, 192
    s_cselect_b32 s4, 0, 40
    s_cselect_b32 s5, s5, 48
    s_load_dwordx2 s[16:17], s[0:1], s4
    s_load_dwordx2 s[20:21], s[0:1], s5
    s_load_dwordx2 s[64:65], s[0:1], 56
    s_load_dwordx2 s[24:25], s[0:1], 80
    s_load_dwordx2 s[68:69], s[0:1], 72
    v_lshrrev_b32 v1, 6, v0
    s_and_b32 s9, s2, 7
    v_readfirstlane_b32 s8, v1
    s_lshr_b32 s3, s2, 3
    s_cmp_lg_u32 s8, 0
    s_cbranch_scc1 F_nocpf
    s_getpc_b64 s[58:59]
F_pc:
    s_lshl_b32 s60, s3, 4
    v_and_b32 v12, 15, v0
    v_add_u32 v12, s60, v12
    v_lshlrev_b32 v12, 7, v12
    v_min_u32 v12, F_end-F_pc, v12
    v_mov_b32 v13, s59
    v_add_co_u32 v12, vcc, s58, v12
    s_nop 1
    v_addc_co_u32 v13, vcc, 0, v13, vcc
    global_load_dword v200, v[12:13], off
F_nocpf:
    s_and_b32 s4, s3, 3
    s_lshl_b32 s10, s9, 1
    s_and_b32 s10, s10, 12
    s_add_u32 s10, s10, s4
    s_lshr_b32 s4, s3, 2
    s_add_u32 s12, s3, s4
    s_and_b32 s4, s4, 1
    s_lshl_b32 s11, s9, 1
    s_and_b32 s11, s11, 2
    s_cmp_ge_u32 s2, 192
    s_cselect_b32 s5, s11, 0
    s_add_u32 s12, s12, s5
    s_and_b32 s12, s12, 3
    s_add_u32 s11, s11, s4
    s_lshr_b32 s9, s3, 3
    s_mov_b32 s26, 23068672
    s_mov_b32 s27, 0x20000
    s_mov_b32 s18, 0x200000
    s_mov_b32 s19, 0x20000
    s_mov_b32 s23, 0x20000
    v_and_b32 v1, 63, v0
    v_and_b32 v2, 31, v0
    v_bfe_u32 v3, v0, 5, 1
    s_cmp_lt_u32 s8, 4
    s_cbranch_scc1 F_comp
    s_sub_u32 s13, s8, 4
    v_lshrrev_b32 v4, 3, v1
    v_and_b32 v5, 7, v1
    v_lshrrev_b32 v6, 4, v1
    v_xor_b32 v5, v5, v6
    v_lshlrev_b32 v5, 4, v5
    s_mov_b64 s[36:37], -1
    s_cmp_eq_u32 s9, 3
    s_cbranch_scc1 F_ldf
    s_mov_b32 s22, 1572864
    v_lshl_add_u32 v8, v4, 10, v5
    v_xor_b32 v9, 64, v8
    v_and_b32 v7, 15, v1
    v_lshlrev_b32 v10, 2, v6
    v_xor_b32 v7, v7, v10
    v_lshlrev_b32 v7, 4, v7
    v_mul_u32_u24 v10, 3072, v6
    v_add_u32 v10, v10, v7
    s_cmp_lt_u32 s9, 0
    s_cselect_b32 s3, 896, 0
    s_cselect_b32 s4, 7, 8
    v_lshrrev_b32 v7, 7, v7
    v_mad_u32_u24 v10, v7, s3, v10
    v_mov_b32 v11, v10
    s_lshl_b32 s28, s10, 17
    s_lshl_b32 s3, s13, 15
    s_add_u32 s28, s28, s3
    s_movk_i32 s30, 0x2000
    s_lshl_b32 s29, s9, 2
    s_add_u32 s29, s29, s11
    s_lshl_b32 s29, s29, s4
    s_mul_i32 s3, s13, 49152
    s_add_u32 s29, s29, s3
    s_movk_i32 s31, 12288
    s_mov_b32 s32, 196608
    s_and_b32 s3, s10, 3
    s_min_u32 s7, s3, s9
    s_and_b32 s3, s10, 4
    s_xor_b32 s12, s12, s3
    s_mov_b32 s35, 0x76543210
    s_cmp_lg_u32 s7, 0
    s_cselect_b32 s35, 0x73625140, s35
    s_cselect_b32 s3, 0, 0
    s_xor_b32 s12, s12, s3
    s_branch F_ldgo
F_ldf:
    s_mov_b32 s22, 524288
    v_lshl_add_u32 v8, v4, 16, v5
    v_xor_b32 v9, 64, v8
    v_lshl_add_u32 v10, v4, 11, v5
    v_xor_b32 v11, 64, v10
    s_lshl_b32 s28, s10, 2
    s_add_u32 s28, s28, s13
    s_lshl_b32 s28, s28, 10
    s_mov_b32 s30, 0x80000
    s_and_b32 s29, s11, 1
    s_lshl_b32 s29, s29, 10
    s_lshl_b32 s3, s13, 16
    s_add_u32 s29, s29, s3
    s_movk_i32 s31, 0x4000
    s_movk_i32 s32, 128
    s_mov_b32 s7, 1
    s_mov_b32 s35, 0x73516240
    s_lshl_b32 s3, s13, 4
    s_add_u32 s3, s3, s11
    s_cmp_eq_u32 s3, 2
    s_cbranch_scc0 F_ldgo
    s_mov_b32 s36, 0xffffff00
    v_mov_b32 v12, 0xbf803f80
    v_lshlrev_b32 v13, 2, v2
    v_lshl_add_u32 v13, v3, 14, v13
    v_add_u32 v13, 65536, v13
    ds_write_b32 v13, v12
    ds_write_b32 v13, v12 offset:32768
F_ldgo:
    s_lshl_b32 s33, s13, 12
    s_mov_b32 s34, s12
    s_waitcnt lgkmcnt(0)
    s_cmp_eq_u32 s9, 3
    s_cbranch_scc1 F_ld0
    s_lshl_b32 s38, s34, 7
    s_add_u32 s38, s38, s28
    s_mul_i32 s39, s34, s32
    s_add_u32 s39, s39, s29
    s_bfe_u32 s34, s35, 262148
    s_xor_b32 s34, s34, s12
    s_add_u32 m0, s33, 0
    s_nop 0
    buffer_load_dwordx4 v8, s[16:19], s38 offen  lds
    s_add_u32 m0, s33, 65536
    s_add_u32 s38, s38, s30
    s_mov_b64 exec, s[36:37]
    buffer_load_dwordx4 v10, s[20:23], s39 offen  lds
    s_mov_b64 exec, -1
    s_add_u32 m0, s33, 1024
    s_add_u32 s39, s39, s31
    buffer_load_dwordx4 v9, s[16:19], s38 offen  lds
    s_add_u32 m0, s33, 66560
    s_add_u32 s38, s38, s30
    buffer_load_dwordx4 v11, s[20:23], s39 offen  lds
    s_add_u32 m0, s33, 2048
    s_add_u32 s39, s39, s31
    buffer_load_dwordx4 v8, s[16:19], s38 offen  lds
    s_add_u32 m0, s33, 67584
    s_add_u32 s38, s38, s30
    buffer_load_dwordx4 v10, s[20:23], s39 offen  lds
    s_add_u32 m0, s33, 3072
    s_add_u32 s39, s39, s31
    buffer_load_dwordx4 v9, s[16:19], s38 offen  lds
    s_add_u32 m0, s33, 68608
    s_add_u32 s38, s38, s30
    buffer_load_dwordx4 v11, s[20:23], s39 offen  lds
F_ld0:
    s_mov_b32 s66, 0x80000
    s_mov_b32 s67, 0x20000
    s_lshr_b32 s58, s2, 3
    s_lshr_b32 s63, s58, 2
    s_lshl_b32 s63, s63, 1
    s_and_b32 s59, s58, 1
    s_add_u32 s63, s63, s59
    s_add_u32 s63, s63, 4
    s_and_b32 s59, s58, 2
    s_min_u32 s59, s59, s9
    s_and_b32 s58, s58, 7
    s_cmp_eq_u32 s9, 3
    s_cselect_b32 s63, s58, s63
    s_cselect_b32 s59, 1, s59
    s_lshl_b32 s63, s63, 3
    s_and_b32 s58, s2, 7
    s_add_u32 s63, s63, s58
    s_lshl_b32 s63, s63, 2
    s_add_u32 s63, s63, s13
    s_cmp_eq_u32 s59, 0
    s_cselect_b64 s[70:71], 0, -1
    s_cbranch_scc1 F_nowo
    s_and_b32 s58, s63, 31
    s_lshl_b32 s58, s58, 14
    s_lshr_b32 s59, s63, 5
    s_lshl_b32 s59, s59, 6
    s_add_u32 s58, s58, s59
    v_and_b32 v12, 3, v2
    v_lshrrev_b32 v13, 3, v2
    v_lshl_add_u32 v12, v13, 2, v12
    v_bfe_u32 v13, v2, 2, 1
    v_lshl_add_u32 v12, v13, 4, v12
    v_lshlrev_b32 v12, 1, v12
    v_lshl_add_u32 v12, v3, 12, v12
    s_add_u32 s59, s58, 0x2000
    buffer_load_ushort v32, v12, s[64:67], s58 offen offset:0
    buffer_load_ushort v33, v12, s[64:67], s58 offen offset:1024
    buffer_load_ushort v34, v12, s[64:67], s58 offen offset:2048
    buffer_load_ushort v35, v12, s[64:67], s58 offen offset:3072
    buffer_load_ushort v36, v12, s[64:67], s59 offen offset:0
    buffer_load_ushort v37, v12, s[64:67], s59 offen offset:1024
    buffer_load_ushort v38, v12, s[64:67], s59 offen offset:2048
    buffer_load_ushort v39, v12, s[64:67], s59 offen offset:3072
F_nowo:
    s_and_b32 s58, s2, 7
    s_lshr_b32 s59, s2, 3
    s_lshl_b32 s50, s58, 2
    s_and_b32 s60, s59, 3
    s_add_u32 s50, s50, s60
    s_lshr_b32 s51, s59, 2
    s_and_b32 s53, s58, 3
    s_cmp_ge_u32 s59, 16
    s_cselect_b32 s61, 7, 0
    s_xor_b32 s53, s53, s61
    s_and_b32 s54, s59, 7
    s_lshl_b32 s54, s54, 1
    s_lshr_b32 s61, s58, 2
    s_add_u32 s54, s54, s61
    s_lshr_b32 s60, s59, 2
    s_and_b32 s60, s60, 2
    s_sub_u32 s61, 32, s54
    s_cmp_eq_u32 s54, 0
    s_cselect_b32 s61, 16, s61
    s_cmp_lt_u32 s60, 2
    s_cselect_b32 s52, s54, s61
    s_mov_b32 s14, 0
    v_and_b32 v12, 11, v1
    v_cmp_eq_u32 vcc, 0, v12
    v_mov_b32 v13, 0x4f804f80
    v_subrev_u32 v12, 0x100, v0
    v_cndmask_b32 v20, 0, v13, vcc
    v_lshlrev_b32 v12, 4, v12
    v_mov_b32 v21, v20
    v_mov_b32 v22, v20
    v_mov_b32 v23, v20
    v_add_u32 v12, 131072, v12
    ds_write_b128 v12, v[20:23]
    ds_write_b128 v12, v[20:23] offset:4096
    ds_write_b128 v12, v[20:23] offset:6144
    v_and_b32 v12, 15, v1
    v_lshlrev_b32 v12, 2, v12
    v_add_u32 v12, 157696, v12
    v_mov_b32 v13, 0
    ds_write_b32 v12, v13
    s_and_b32 s58, s13, 1
    s_lshr_b32 s59, s13, 1
    s_lshl_b32 s60, s59, 4
    v_xor_b32 v12, s60, v2
    s_lshl_b32 s60, s58, 10
    s_add_u32 s60, s60, s52
    v_lshl_add_u32 v12, v12, 5, s60
    s_lshl_b32 s60, s59, 5
    v_lshl_add_u32 v13, v3, 2, s60
    v_mul_u32_u24 v13, v12, v13
    v_lshlrev_b32 v14, 2, v12
    s_mov_b32 s40, 1.0
    s_mov_b32 s41, 0
    s_mov_b32 s42, -1.0
    s_cmp_gt_u32 s52, 16
    s_cselect_b32 s42, 1.0, s42
    s_cmp_eq_u32 s54, 0
    s_cselect_b32 s42, 0, s42
    s_cmp_eq_u32 s52, 16
    s_cselect_b32 s40, 0, s40
    s_cselect_b32 s41, 1.0, s41
    s_cmp_ge_u32 s53, 4
    s_cselect_b32 s46, 0x80000000, 0
    s_xor_b32 s43, s40, s46
    s_xor_b32 s44, s41, s46
    s_xor_b32 s45, s42, s46
    s_xor_b32 s45, s45, 0x80000000
    v_and_b32 v24, 0x7ff, v13
    v_cvt_f32_u32 v24, v24
    v_mul_f32 v24, 0x3a000000, v24
    v_cos_f32 v25, v24
    v_sin_f32 v26, v24
    v_add_u32 v13, v13, v12
    v_mul_f32 v27, s40, v25
    v_mul_f32 v28, s42, v26
    v_fmac_f32 v28, s41, v25
    v_cvt_pk_bf16_f32 v88, v27, v28
    v_mul_f32 v27, s43, v26
    v_mul_f32 v28, s45, v25
    v_fmac_f32 v28, s44, v26
    v_cvt_pk_bf16_f32 v92, v27, v28
    v_and_b32 v24, 0x7ff, v13
    v_cvt_f32_u32 v24, v24
    v_mul_f32 v24, 0x3a000000, v24
    v_cos_f32 v25, v24
    v_sin_f32 v26, v24
    v_add_u32 v13, v13, v12
    v_mul_f32 v27, s40, v25
    v_mul_f32 v28, s42, v26
    v_fmac_f32 v28, s41, v25
    v_cvt_pk_bf16_f32 v89, v27, v28
    v_mul_f32 v27, s43, v26
    v_mul_f32 v28, s45, v25
    v_fmac_f32 v28, s44, v26
    v_cvt_pk_bf16_f32 v93, v27, v28
    v_and_b32 v24, 0x7ff, v13
    v_cvt_f32_u32 v24, v24
    v_mul_f32 v24, 0x3a000000, v24
    v_cos_f32 v25, v24
    v_sin_f32 v26, v24
    v_add_u32 v13, v13, v12
    v_mul_f32 v27, s40, v25
    v_mul_f32 v28, s42, v26
    v_fmac_f32 v28, s41, v25
    v_cvt_pk_bf16_f32 v90, v27, v28
    v_mul_f32 v27, s43, v26
    v_mul_f32 v28, s45, v25
    v_fmac_f32 v28, s44, v26
    v_cvt_pk_bf16_f32 v94, v27, v28
    v_and_b32 v24, 0x7ff, v13
    v_cvt_f32_u32 v24, v24
    v_mul_f32 v24, 0x3a000000, v24
    v_cos_f32 v25, v24
    v_sin_f32 v26, v24
    v_add_u32 v13, v13, v12
    v_mul_f32 v27, s40, v25
    v_mul_f32 v28, s42, v26
    v_fmac_f32 v28, s41, v25
    v_cvt_pk_bf16_f32 v91, v27, v28
    v_mul_f32 v27, s43, v26
    v_mul_f32 v28, s45, v25
    v_fmac_f32 v28, s44, v26
    v_cvt_pk_bf16_f32 v95, v27, v28
    v_add_u32 v13, v13, v14
    v_and_b32 v24, 0x7ff, v13
    v_cvt_f32_u32 v24, v24
    v_mul_f32 v24, 0x3a000000, v24
    v_cos_f32 v25, v24
    v_sin_f32 v26, v24
    v_add_u32 v13, v13, v12
    v_mul_f32 v27, s40, v25
    v_mul_f32 v28, s42, v26
    v_fmac_f32 v28, s41, v25
    v_cvt_pk_bf16_f32 v96, v27, v28
    v_mul_f32 v27, s43, v26
    v_mul_f32 v28, s45, v25
    v_fmac_f32 v28, s44, v26
    v_cvt_pk_bf16_f32 v100, v27, v28
    v_and_b32 v24, 0x7ff, v13
    v_cvt_f32_u32 v24, v24
    v_mul_f32 v24, 0x3a000000, v24
    v_cos_f32 v25, v24
    v_sin_f32 v26, v24
    v_add_u32 v13, v13, v12
    v_mul_f32 v27, s40, v25
    v_mul_f32 v28, s42, v26
    v_fmac_f32 v28, s41, v25
    v_cvt_pk_bf16_f32 v97, v27, v28
    v_mul_f32 v27, s43, v26
    v_mul_f32 v28, s45, v25
    v_fmac_f32 v28, s44, v26
    v_cvt_pk_bf16_f32 v101, v27, v28
    v_and_b32 v24, 0x7ff, v13
    v_cvt_f32_u32 v24, v24
    v_mul_f32 v24, 0x3a000000, v24
    v_cos_f32 v25, v24
    v_sin_f32 v26, v24
    v_add_u32 v13, v13, v12
    v_mul_f32 v27, s40, v25
    v_mul_f32 v28, s42, v26
    v_fmac_f32 v28, s41, v25
    v_cvt_pk_bf16_f32 v98, v27, v28
    v_mul_f32 v27, s43, v26
    v_mul_f32 v28, s45, v25
    v_fmac_f32 v28, s44, v26
    v_cvt_pk_bf16_f32 v102, v27, v28
    v_and_b32 v24, 0x7ff, v13
    v_cvt_f32_u32 v24, v24
    v_mul_f32 v24, 0x3a000000, v24
    v_cos_f32 v25, v24
    v_sin_f32 v26, v24
    v_add_u32 v13, v13, v12
    v_mul_f32 v27, s40, v25
    v_mul_f32 v28, s42, v26
    v_fmac_f32 v28, s41, v25
    v_cvt_pk_bf16_f32 v99, v27, v28
    v_mul_f32 v27, s43, v26
    v_mul_f32 v28, s45, v25
    v_fmac_f32 v28, s44, v26
    v_cvt_pk_bf16_f32 v103, v27, v28
    v_add_u32 v13, v13, v14
    v_and_b32 v24, 0x7ff, v13
    v_cvt_f32_u32 v24, v24
    v_mul_f32 v24, 0x3a000000, v24
    v_cos_f32 v25, v24
    v_sin_f32 v26, v24
    v_add_u32 v13, v13, v12
    v_mul_f32 v27, s40, v25
    v_mul_f32 v28, s42, v26
    v_fmac_f32 v28, s41, v25
    v_cvt_pk_bf16_f32 v104, v27, v28
    v_mul_f32 v27, s43, v26
    v_mul_f32 v28, s45, v25
    v_fmac_f32 v28, s44, v26
    v_cvt_pk_bf16_f32 v108, v27, v28
    v_and_b32 v24, 0x7ff, v13
    v_cvt_f32_u32 v24, v24
    v_mul_f32 v24, 0x3a000000, v24
    v_cos_f32 v25, v24
    v_sin_f32 v26, v24
    v_add_u32 v13, v13, v12
    v_mul_f32 v27, s40, v25
    v_mul_f32 v28, s42, v26
    v_fmac_f32 v28, s41, v25
    v_cvt_pk_bf16_f32 v105, v27, v28
    v_mul_f32 v27, s43, v26
    v_mul_f32 v28, s45, v25
    v_fmac_f32 v28, s44, v26
    v_cvt_pk_bf16_f32 v109, v27, v28
    v_and_b32 v24, 0x7ff, v13
    v_cvt_f32_u32 v24, v24
    v_mul_f32 v24, 0x3a000000, v24
    v_cos_f32 v25, v24
    v_sin_f32 v26, v24
    v_add_u32 v13, v13, v12
    v_mul_f32 v27, s40, v25
    v_mul_f32 v28, s42, v26
    v_fmac_f32 v28, s41, v25
    v_cvt_pk_bf16_f32 v106, v27, v28
    v_mul_f32 v27, s43, v26
    v_mul_f32 v28, s45, v25
    v_fmac_f32 v28, s44, v26
    v_cvt_pk_bf16_f32 v110, v27, v28
    v_and_b32 v24, 0x7ff, v13
    v_cvt_f32_u32 v24, v24
    v_mul_f32 v24, 0x3a000000, v24
    v_cos_f32 v25, v24
    v_sin_f32 v26, v24
    v_add_u32 v13, v13, v12
    v_mul_f32 v27, s40, v25
    v_mul_f32 v28, s42, v26
    v_fmac_f32 v28, s41, v25
    v_cvt_pk_bf16_f32 v107, v27, v28
    v_mul_f32 v27, s43, v26
    v_mul_f32 v28, s45, v25
    v_fmac_f32 v28, s44, v26
    v_cvt_pk_bf16_f32 v111, v27, v28
    v_add_u32 v13, v13, v14
    v_and_b32 v24, 0x7ff, v13
    v_cvt_f32_u32 v24, v24
    v_mul_f32 v24, 0x3a000000, v24
    v_cos_f32 v25, v24
    v_sin_f32 v26, v24
    v_add_u32 v13, v13, v12
    v_mul_f32 v27, s40, v25
    v_mul_f32 v28, s42, v26
    v_fmac_f32 v28, s41, v25
    v_cvt_pk_bf16_f32 v112, v27, v28
    v_mul_f32 v27, s43, v26
    v_mul_f32 v28, s45, v25
    v_fmac_f32 v28, s44, v26
    v_cvt_pk_bf16_f32 v116, v27, v28
    v_and_b32 v24, 0x7ff, v13
    v_cvt_f32_u32 v24, v24
    v_mul_f32 v24, 0x3a000000, v24
    v_cos_f32 v25, v24
    v_sin_f32 v26, v24
    v_add_u32 v13, v13, v12
    v_mul_f32 v27, s40, v25
    v_mul_f32 v28, s42, v26
    v_fmac_f32 v28, s41, v25
    v_cvt_pk_bf16_f32 v113, v27, v28
    v_mul_f32 v27, s43, v26
    v_mul_f32 v28, s45, v25
    v_fmac_f32 v28, s44, v26
    v_cvt_pk_bf16_f32 v117, v27, v28
    v_and_b32 v24, 0x7ff, v13
    v_cvt_f32_u32 v24, v24
    v_mul_f32 v24, 0x3a000000, v24
    v_cos_f32 v25, v24
    v_sin_f32 v26, v24
    v_add_u32 v13, v13, v12
    v_mul_f32 v27, s40, v25
    v_mul_f32 v28, s42, v26
    v_fmac_f32 v28, s41, v25
    v_cvt_pk_bf16_f32 v114, v27, v28
    v_mul_f32 v27, s43, v26
    v_mul_f32 v28, s45, v25
    v_fmac_f32 v28, s44, v26
    v_cvt_pk_bf16_f32 v118, v27, v28
    v_and_b32 v24, 0x7ff, v13
    v_cvt_f32_u32 v24, v24
    v_mul_f32 v24, 0x3a000000, v24
    v_cos_f32 v25, v24
    v_sin_f32 v26, v24
    v_add_u32 v13, v13, v12
    v_mul_f32 v27, s40, v25
    v_mul_f32 v28, s42, v26
    v_fmac_f32 v28, s41, v25
    v_cvt_pk_bf16_f32 v115, v27, v28
    v_mul_f32 v27, s43, v26
    v_mul_f32 v28, s45, v25
    v_fmac_f32 v28, s44, v26
    v_cvt_pk_bf16_f32 v119, v27, v28
    s_cmp_eq_u32 s9, 3
    s_cbranch_scc1 F_ldf2
    s_cmp_lg_u32 s7, 0
    s_cbranch_scc1 F_ldf3
    s_lshl_b32 s38, s34, 7
    s_add_u32 s38, s38, s28
    s_mul_i32 s39, s34, s32
    s_add_u32 s39, s39, s29
    s_bfe_u32 s34, s35, 262152
    s_xor_b32 s34, s34, s12
    s_add_u32 m0, s33, 16384
    s_nop 0
    buffer_load_dwordx4 v8, s[16:19], s38 offen  lds
    s_add_u32 m0, s33, 81920
    s_add_u32 s38, s38, s30
    s_mov_b64 exec, s[36:37]
    buffer_load_dwordx4 v10, s[20:23], s39 offen  lds
    s_mov_b64 exec, -1
    s_add_u32 m0, s33, 17408
    s_add_u32 s39, s39, s31
    buffer_load_dwordx4 v9, s[16:19], s38 offen  lds
    s_add_u32 m0, s33, 82944
    s_add_u32 s38, s38, s30
    buffer_load_dwordx4 v11, s[20:23], s39 offen  lds
    s_add_u32 m0, s33, 18432
    s_add_u32 s39, s39, s31
    buffer_load_dwordx4 v8, s[16:19], s38 offen  lds
    s_add_u32 m0, s33, 83968
    s_add_u32 s38, s38, s30
    buffer_load_dwordx4 v10, s[20:23], s39 offen  lds
    s_add_u32 m0, s33, 19456
    s_add_u32 s39, s39, s31
    buffer_load_dwordx4 v9, s[16:19], s38 offen  lds
    s_add_u32 m0, s33, 84992
    s_add_u32 s38, s38, s30
    buffer_load_dwordx4 v11, s[20:23], s39 offen  lds
    s_waitcnt vmcnt(8)
    s_barrier
    s_lshl_b32 s38, s34, 7
    s_add_u32 s38, s38, s28
    s_mul_i32 s39, s34, s32
    s_add_u32 s39, s39, s29
    s_bfe_u32 s34, s35, 262156
    s_xor_b32 s34, s34, s12
    s_add_u32 m0, s33, 32768
    s_nop 0
    buffer_load_dwordx4 v8, s[16:19], s38 offen  lds
    s_add_u32 m0, s33, 98304
    s_add_u32 s38, s38, s30
    s_mov_b64 exec, s[36:37]
    buffer_load_dwordx4 v10, s[20:23], s39 offen  lds
    s_mov_b64 exec, -1
    s_add_u32 m0, s33, 33792
    s_add_u32 s39, s39, s31
    buffer_load_dwordx4 v9, s[16:19], s38 offen  lds
    s_add_u32 m0, s33, 99328
    s_add_u32 s38, s38, s30
    buffer_load_dwordx4 v11, s[20:23], s39 offen  lds
    s_add_u32 m0, s33, 34816
    s_add_u32 s39, s39, s31
    buffer_load_dwordx4 v8, s[16:19], s38 offen  lds
    s_add_u32 m0, s33, 100352
    s_add_u32 s38, s38, s30
    buffer_load_dwordx4 v10, s[20:23], s39 offen  lds
    s_add_u32 m0, s33, 35840
    s_add_u32 s39, s39, s31
    buffer_load_dwordx4 v9, s[16:19], s38 offen  lds
    s_add_u32 m0, s33, 101376
    s_add_u32 s38, s38, s30
    buffer_load_dwordx4 v11, s[20:23], s39 offen  lds
    s_waitcnt vmcnt(8)
    s_barrier
    s_lshl_b32 s38, s34, 7
    s_add_u32 s38, s38, s28
    s_mul_i32 s39, s34, s32
    s_add_u32 s39, s39, s29
    s_bfe_u32 s34, s35, 262160
    s_xor_b32 s34, s34, s12
    s_add_u32 m0, s33, 49152
    s_nop 0
    buffer_load_dwordx4 v8, s[16:19], s38 offen  lds
    s_add_u32 m0, s33, 114688
    s_add_u32 s38, s38, s30
    s_mov_b64 exec, s[36:37]
    buffer_load_dwordx4 v10, s[20:23], s39 offen  lds
    s_mov_b64 exec, -1
    s_add_u32 m0, s33, 50176
    s_add_u32 s39, s39, s31
    buffer_load_dwordx4 v9, s[16:19], s38 offen  lds
    s_add_u32 m0, s33, 115712
    s_add_u32 s38, s38, s30
    buffer_load_dwordx4 v11, s[20:23], s39 offen  lds
    s_add_u32 m0, s33, 51200
    s_add_u32 s39, s39, s31
    buffer_load_dwordx4 v8, s[16:19], s38 offen  lds
    s_add_u32 m0, s33, 116736
    s_add_u32 s38, s38, s30
    buffer_load_dwordx4 v10, s[20:23], s39 offen  lds
    s_add_u32 m0, s33, 52224
    s_add_u32 s39, s39, s31
    buffer_load_dwordx4 v9, s[16:19], s38 offen  lds
    s_add_u32 m0, s33, 117760
    s_add_u32 s38, s38, s30
    buffer_load_dwordx4 v11, s[20:23], s39 offen  lds
    s_waitcnt vmcnt(8)
    s_barrier
    s_lshl_b32 s38, s34, 7
    s_add_u32 s38, s38, s28
    s_mul_i32 s39, s34, s32
    s_add_u32 s39, s39, s29
    s_bfe_u32 s34, s35, 262164
    s_xor_b32 s34, s34, s12
    s_add_u32 m0, s33, 0
    s_nop 0
    buffer_load_dwordx4 v8, s[16:19], s38 offen  lds
    s_add_u32 m0, s33, 65536
    s_add_u32 s38, s38, s30
    s_mov_b64 exec, s[36:37]
    buffer_load_dwordx4 v10, s[20:23], s39 offen  lds
    s_mov_b64 exec, -1
    s_add_u32 m0, s33, 1024
    s_add_u32 s39, s39, s31
    buffer_load_dwordx4 v9, s[16:19], s38 offen  lds
    s_add_u32 m0, s33, 66560
    s_add_u32 s38, s38, s30
    buffer_load_dwordx4 v11, s[20:23], s39 offen  lds
    s_add_u32 m0, s33, 2048
    s_add_u32 s39, s39, s31
    buffer_load_dwordx4 v8, s[16:19], s38 offen  lds
    s_add_u32 m0, s33, 67584
    s_add_u32 s38, s38, s30
    buffer_load_dwordx4 v10, s[20:23], s39 offen  lds
    s_add_u32 m0, s33, 3072
    s_add_u32 s39, s39, s31
    buffer_load_dwordx4 v9, s[16:19], s38 offen  lds
    s_add_u32 m0, s33, 68608
    s_add_u32 s38, s38, s30
    buffer_load_dwordx4 v11, s[20:23], s39 offen  lds
    s_waitcnt vmcnt(8)
    s_barrier
    s_lshl_b32 s38, s34, 7
    s_add_u32 s38, s38, s28
    s_mul_i32 s39, s34, s32
    s_add_u32 s39, s39, s29
    s_bfe_u32 s34, s35, 262168
    s_xor_b32 s34, s34, s12
    s_add_u32 m0, s33, 16384
    s_nop 0
    buffer_load_dwordx4 v8, s[16:19], s38 offen  lds
    s_add_u32 m0, s33, 81920
    s_add_u32 s38, s38, s30
    s_mov_b64 exec, s[36:37]
    buffer_load_dwordx4 v10, s[20:23], s39 offen  lds
    s_mov_b64 exec, -1
    s_add_u32 m0, s33, 17408
    s_add_u32 s39, s39, s31
    buffer_load_dwordx4 v9, s[16:19], s38 offen  lds
    s_add_u32 m0, s33, 82944
    s_add_u32 s38, s38, s30
    buffer_load_dwordx4 v11, s[20:23], s39 offen  lds
    s_add_u32 m0, s33, 18432
    s_add_u32 s39, s39, s31
    buffer_load_dwordx4 v8, s[16:19], s38 offen  lds
    s_add_u32 m0, s33, 83968
    s_add_u32 s38, s38, s30
    buffer_load_dwordx4 v10, s[20:23], s39 offen  lds
    s_add_u32 m0, s33, 19456
    s_add_u32 s39, s39, s31
    buffer_load_dwordx4 v9, s[16:19], s38 offen  lds
    s_add_u32 m0, s33, 84992
    s_add_u32 s38, s38, s30
    buffer_load_dwordx4 v11, s[20:23], s39 offen  lds
    s_waitcnt vmcnt(8)
    s_barrier
    s_lshl_b32 s38, s34, 7
    s_add_u32 s38, s38, s28
    s_mul_i32 s39, s34, s32
    s_add_u32 s39, s39, s29
    s_bfe_u32 s34, s35, 262172
    s_xor_b32 s34, s34, s12
    s_add_u32 m0, s33, 32768
    s_nop 0
    buffer_load_dwordx4 v8, s[16:19], s38 offen  lds
    s_add_u32 m0, s33, 98304
    s_add_u32 s38, s38, s30
    s_mov_b64 exec, s[36:37]
    buffer_load_dwordx4 v10, s[20:23], s39 offen  lds
    s_mov_b64 exec, -1
    s_add_u32 m0, s33, 33792
    s_add_u32 s39, s39, s31
    buffer_load_dwordx4 v9, s[16:19], s38 offen  lds
    s_add_u32 m0, s33, 99328
    s_add_u32 s38, s38, s30
    buffer_load_dwordx4 v11, s[20:23], s39 offen  lds
    s_add_u32 m0, s33, 34816
    s_add_u32 s39, s39, s31
    buffer_load_dwordx4 v8, s[16:19], s38 offen  lds
    s_add_u32 m0, s33, 100352
    s_add_u32 s38, s38, s30
    buffer_load_dwordx4 v10, s[20:23], s39 offen  lds
    s_add_u32 m0, s33, 35840
    s_add_u32 s39, s39, s31
    buffer_load_dwordx4 v9, s[16:19], s38 offen  lds
    s_add_u32 m0, s33, 101376
    s_add_u32 s38, s38, s30
    buffer_load_dwordx4 v11, s[20:23], s39 offen  lds
    s_waitcnt vmcnt(8)
    s_barrier
    s_lshl_b32 s38, s34, 7
    s_add_u32 s38, s38, s28
    s_mul_i32 s39, s34, s32
    s_add_u32 s39, s39, s29
    s_bfe_u32 s34, s35, 262144
    s_xor_b32 s34, s34, s12
    s_add_u32 m0, s33, 49152
    s_nop 0
    buffer_load_dwordx4 v8, s[16:19], s38 offen  lds
    s_add_u32 m0, s33, 114688
    s_add_u32 s38, s38, s30
    s_mov_b64 exec, s[36:37]
    buffer_load_dwordx4 v10, s[20:23], s39 offen  lds
    s_mov_b64 exec, -1
    s_add_u32 m0, s33, 50176
    s_add_u32 s39, s39, s31
    buffer_load_dwordx4 v9, s[16:19], s38 offen  lds
    s_add_u32 m0, s33, 115712
    s_add_u32 s38, s38, s30
    buffer_load_dwordx4 v11, s[20:23], s39 offen  lds
    s_add_u32 m0, s33, 51200
    s_add_u32 s39, s39, s31
    buffer_load_dwordx4 v8, s[16:19], s38 offen  lds
    s_add_u32 m0, s33, 116736
    s_add_u32 s38, s38, s30
    buffer_load_dwordx4 v10, s[20:23], s39 offen  lds
    s_add_u32 m0, s33, 52224
    s_add_u32 s39, s39, s31
    buffer_load_dwordx4 v9, s[16:19], s38 offen  lds
    s_add_u32 m0, s33, 117760
    s_add_u32 s38, s38, s30
    buffer_load_dwordx4 v11, s[20:23], s39 offen  lds
F_ldpost:
    v_mov_b32 v203, 0
    global_load_dwordx2 v[204:205], v203, s[68:69] sc1
    s_lshl_b32 s47, s63, 10
    s_add_u32 s47, s47, 12582912
    v_lshl_or_b32 v192, v33, 16, v32
    v_lshl_or_b32 v193, v35, 16, v34
    v_lshl_or_b32 v194, v37, 16, v36
    v_lshl_or_b32 v195, v39, 16, v38
    s_lshl_b32 s58, s53, 5
    v_add_u32 v24, s58, v2
    v_sub_u32 v26, 0x100, v24
    v_sub_u32 v27, 0xff, v24
    s_cmp_ge_u32 s53, 4
    s_cselect_b64 vcc, -1, 0
    v_cndmask_b32 v26, v24, v26, vcc
    v_cndmask_b32 v27, v24, v27, vcc
    v_and_b32 v28, 0x7f, v26
    v_cmp_eq_u32 vcc, 0, v28
    v_mul_u32_u24 v25, 4352, v3
    v_lshl_add_u32 v184, v26, 4, v25
    v_lshl_add_u32 v186, v27, 4, v25
    v_add_u32 v186, 2176, v186
    v_mov_b32 v28, 0x40000000
    v_cndmask_b32 v185, v184, v28, vcc
    v_subrev_u32 v187, 0x100, v0
    v_lshlrev_b32 v187, 7, v187
    v_add_u32 v187, 13631488, v187
    s_mul_i32 s63, s54, 69632
    s_lshr_b32 s58, s13, 1
    s_mul_i32 s58, s58, 34816
    s_add_u32 s63, s63, s58
    s_add_u32 s63, s63, 8388608
    s_waitcnt vmcnt(9)
    s_barrier
    v_bfe_u32 v24, v1, 1, 2
    v_bfe_u32 v25, v1, 3, 1
    v_lshl_add_u32 v24, v24, 1, v25
    v_bfe_u32 v24, v1, 1, 3
    v_and_b32 v25, 1, v1
    v_lshl_add_u32 v24, v25, 5, v24
    s_lshl_b32 s58, s13, 3
    s_add_u32 s58, s58, 32
    v_add_u32 v24, s58, v24
    s_lshl_b32 s58, s51, 2
    s_add_u32 s58, s58, s13
    v_mov_b32 v25, s58
    s_mov_b32 vcc_lo, 0xffff0000
    s_mov_b32 vcc_hi, 0
    v_cndmask_b32 v24, v25, v24, vcc
    s_lshr_b32 s58, s50, 2
    s_lshl_b32 s58, s58, 7
    s_add_u32 s58, s58, 14155776
    v_lshl_add_u32 v190, v24, 10, s58
    s_mov_b64 exec, 0xf8000
    buffer_load_dwordx2 v[188:189], v190, s[24:27], 0 offen sc1
    s_mov_b64 exec, -1
    s_lshl_b32 s57, s13, 11
    s_and_b32 s58, s50, 2
    s_xor_b32 s58, s58, s13
    s_lshl_b32 s58, s58, 11
    s_lshl_b32 s55, s50, 13
    s_add_u32 s55, s55, s58
    s_lshl_b32 s61, s51, 18
    s_add_u32 s61, s61, s55
    v_mov_b32 v176, 0
    v_and_b32 v24, 15, v1
    v_lshlrev_b32 v24, 3, v24
    v_bfe_u32 v25, v1, 4, 1
    s_and_b32 s58, s51, 7
    s_lshr_b32 s58, s58, 2
    v_xor_b32 v25, s58, v25
    v_lshl_add_u32 v218, v25, 14, v24
    s_load_dwordx2 s[20:21], s[0:1], 64
    s_mov_b32 s22, 0x400000
    s_mov_b32 s23, 0x20000
    v_lshlrev_b32 v7, 4, v1
    v_lshlrev_b32 v28, 4, v0
    v_add_u32 v28, 141312, v28
    v_mov_b32 v3, 0xdddd
    v_mov_b32 v1, v7
    v_and_b32 v5, 0xf0, v7
    v_lshrrev_b32 v6, 1, v7
    v_and_b32 v6, 0x100, v6
    v_or_b32 v5, v5, v6
    v_and_b32 v6, 0x100, v7
    v_lshlrev_b32 v6, 8, v6
    v_add_u32 v5, v5, v6
    v_add_u32 v2, 65536, v5
    v_lshrrev_b32 v6, 3, v6
    v_sub_u32 v4, 0x2000, v6
    v_mov_b32 v72, 0
    v_mov_b32 v73, 0
    v_mov_b32 v74, 0
    v_mov_b32 v75, 0
    v_mov_b32 v76, 0
    v_mov_b32 v77, 0
    v_mov_b32 v78, 0
    v_mov_b32 v79, 0
    v_mov_b32 v80, 0
    v_mov_b32 v81, 0
    v_mov_b32 v82, 0
    v_mov_b32 v83, 0
    v_mov_b32 v84, 0
    v_mov_b32 v85, 0
    v_mov_b32 v86, 0
    v_mov_b32 v87, 0
    v_mov_b32 v220, -1
    v_mov_b32 v221, -1
    v_mov_b32 v222, -1
    v_mov_b32 v223, -1
    s_waitcnt vmcnt(1)
    s_barrier
    s_mov_b32 s62, 0
F_tagL_spin:
    s_waitcnt vmcnt(0)
    v_readfirstlane_b32 s48, v204
    v_readfirstlane_b32 s49, v205
    s_cmp_lg_u32 s48, 0
    s_cbranch_scc1 F_tagL_ok
    v_mov_b32 v203, 0
    global_load_dwordx2 v[204:205], v203, s[68:69] sc1
    s_add_u32 s62, s62, 1
    s_cmp_lt_u32 s62, 262144
    s_cbranch_scc1 F_tagL_spin
F_tagL_ok:
    s_cmp_lg_u32 s7, 0
    s_cbranch_scc1 F_nopre
    s_barrier
F_nopre:
    s_mov_b64 exec, 0xf8000
    v_cmp_ne_u64 vcc, s[48:49], v[188:189]
    s_nop 0
    s_cbranch_vccz F_h1_ok
    s_mov_b32 s62, 0
F_h1_spin:
    buffer_load_dwordx2 v[188:189], v190, s[24:27], 0 offen sc1
    s_waitcnt vmcnt(0)
    v_cmp_ne_u64 vcc, s[48:49], v[188:189]
    s_add_u32 s62, s62, 1
    s_cbranch_vccz F_h1_ok
    s_cmp_lt_u32 s62, 262144
    s_cbranch_scc1 F_h1_spin
F_h1_ok:
    s_mov_b64 exec, -1
    s_add_u32 m0, s57, 0
    s_add_u32 s67, s55, 2097152
    buffer_load_dwordx4 v7, s[24:27], s67 offen offset:0 sc1 lds
    buffer_load_dwordx4 v7, s[24:27], s67 offen offset:1024 sc1 lds
    s_add_u32 m0, s57, 141312
    s_nop 0
    buffer_load_dwordx4 v7, s[24:27], s61 offen offset:0 sc1 lds
    buffer_load_dwordx4 v7, s[24:27], s61 offen offset:1024 sc1 lds
    s_add_u32 m0, s57, 65536
    s_add_u32 s67, s55, 4194304
    buffer_load_dwordx4 v7, s[24:27], s67 offen offset:0 sc1 lds
    buffer_load_dwordx4 v7, s[24:27], s67 offen offset:1024 sc1 lds
    s_add_u32 m0, s57, 8192
    s_add_u32 s67, s55, 2359296
    buffer_load_dwordx4 v7, s[24:27], s67 offen offset:0 sc1 lds
    buffer_load_dwordx4 v7, s[24:27], s67 offen offset:1024 sc1 lds
    s_add_u32 m0, s57, 73728
    s_add_u32 s67, s55, 4456448
    buffer_load_dwordx4 v7, s[24:27], s67 offen offset:0 sc1 lds
    buffer_load_dwordx4 v7, s[24:27], s67 offen offset:1024 sc1 lds
    s_mov_b32 s15, 0
    s_waitcnt vmcnt(0)
    s_branch F_b2
F_ldf2:
    s_lshl_b32 s38, s34, 7
    s_add_u32 s38, s38, s28
    s_mul_i32 s39, s34, s32
    s_add_u32 s39, s39, s29
    s_bfe_u32 s34, s35, 262148
    s_xor_b32 s34, s34, s12
    s_add_u32 m0, s33, 0
    s_nop 0
    buffer_load_dwordx4 v8, s[16:19], s38 offen  lds
    s_add_u32 m0, s33, 65536
    s_add_u32 s38, s38, s30
    s_mov_b64 exec, s[36:37]
    buffer_load_dwordx4 v10, s[20:23], s39 offen  lds
    s_mov_b64 exec, -1
    s_add_u32 m0, s33, 1024
    s_add_u32 s39, s39, s31
    buffer_load_dwordx4 v9, s[16:19], s38 offen  lds
    s_add_u32 m0, s33, 66560
    s_add_u32 s38, s38, s30
    buffer_load_dwordx4 v11, s[20:23], s39 offen  lds
    s_add_u32 m0, s33, 2048
    s_add_u32 s39, s39, s31
    buffer_load_dwordx4 v8, s[16:19], s38 offen  lds
    s_add_u32 m0, s33, 67584
    s_add_u32 s38, s38, s30
    buffer_load_dwordx4 v10, s[20:23], s39 offen  lds
    s_add_u32 m0, s33, 3072
    s_add_u32 s39, s39, s31
    buffer_load_dwordx4 v9, s[16:19], s38 offen  lds
    s_add_u32 m0, s33, 68608
    s_add_u32 s38, s38, s30
    buffer_load_dwordx4 v11, s[20:23], s39 offen  lds
F_ldf3:
    s_lshl_b32 s38, s34, 7
    s_add_u32 s38, s38, s28
    s_mul_i32 s39, s34, s32
    s_add_u32 s39, s39, s29
    s_bfe_u32 s34, s35, 262152
    s_xor_b32 s34, s34, s12
    s_add_u32 m0, s33, 16384
    s_nop 0
    buffer_load_dwordx4 v8, s[16:19], s38 offen  lds
    s_add_u32 m0, s33, 81920
    s_add_u32 s38, s38, s30
    s_mov_b64 exec, s[36:37]
    buffer_load_dwordx4 v10, s[20:23], s39 offen  lds
    s_mov_b64 exec, -1
    s_add_u32 m0, s33, 17408
    s_add_u32 s39, s39, s31
    buffer_load_dwordx4 v9, s[16:19], s38 offen  lds
    s_add_u32 m0, s33, 82944
    s_add_u32 s38, s38, s30
    buffer_load_dwordx4 v11, s[20:23], s39 offen  lds
    s_add_u32 m0, s33, 18432
    s_add_u32 s39, s39, s31
    buffer_load_dwordx4 v8, s[16:19], s38 offen  lds
    s_add_u32 m0, s33, 83968
    s_add_u32 s38, s38, s30
    buffer_load_dwordx4 v10, s[20:23], s39 offen  lds
    s_add_u32 m0, s33, 19456
    s_add_u32 s39, s39, s31
    buffer_load_dwordx4 v9, s[16:19], s38 offen  lds
    s_add_u32 m0, s33, 84992
    s_add_u32 s38, s38, s30
    buffer_load_dwordx4 v11, s[20:23], s39 offen  lds
    s_lshl_b32 s38, s34, 7
    s_add_u32 s38, s38, s28
    s_mul_i32 s39, s34, s32
    s_add_u32 s39, s39, s29
    s_bfe_u32 s34, s35, 262156
    s_xor_b32 s34, s34, s12
    s_add_u32 m0, s33, 32768
    s_nop 0
    buffer_load_dwordx4 v8, s[16:19], s38 offen  lds
    s_add_u32 m0, s33, 98304
    s_add_u32 s38, s38, s30
    s_mov_b64 exec, s[36:37]
    buffer_load_dwordx4 v10, s[20:23], s39 offen  lds
    s_mov_b64 exec, -1
    s_add_u32 m0, s33, 33792
    s_add_u32 s39, s39, s31
    buffer_load_dwordx4 v9, s[16:19], s38 offen  lds
    s_add_u32 m0, s33, 99328
    s_add_u32 s38, s38, s30
    buffer_load_dwordx4 v11, s[20:23], s39 offen  lds
    s_add_u32 m0, s33, 34816
    s_add_u32 s39, s39, s31
    buffer_load_dwordx4 v8, s[16:19], s38 offen  lds
    s_add_u32 m0, s33, 100352
    s_add_u32 s38, s38, s30
    buffer_load_dwordx4 v10, s[20:23], s39 offen  lds
    s_add_u32 m0, s33, 35840
    s_add_u32 s39, s39, s31
    buffer_load_dwordx4 v9, s[16:19], s38 offen  lds
    s_add_u32 m0, s33, 101376
    s_add_u32 s38, s38, s30
    buffer_load_dwordx4 v11, s[20:23], s39 offen  lds
    s_lshl_b32 s38, s34, 7
    s_add_u32 s38, s38, s28
    s_mul_i32 s39, s34, s32
    s_add_u32 s39, s39, s29
    s_bfe_u32 s34, s35, 262160
    s_xor_b32 s34, s34, s12
    s_add_u32 m0, s33, 49152
    s_nop 0
    buffer_load_dwordx4 v8, s[16:19], s38 offen  lds
    s_add_u32 m0, s33, 114688
    s_add_u32 s38, s38, s30
    s_mov_b64 exec, s[36:37]
    buffer_load_dwordx4 v10, s[20:23], s39 offen  lds
    s_mov_b64 exec, -1
    s_add_u32 m0, s33, 50176
    s_add_u32 s39, s39, s31
    buffer_load_dwordx4 v9, s[16:19], s38 offen  lds
    s_add_u32 m0, s33, 115712
    s_add_u32 s38, s38, s30
    buffer_load_dwordx4 v11, s[20:23], s39 offen  lds
    s_add_u32 m0, s33, 51200
    s_add_u32 s39, s39, s31
    buffer_load_dwordx4 v8, s[16:19], s38 offen  lds
    s_add_u32 m0, s33, 116736
    s_add_u32 s38, s38, s30
    buffer_load_dwordx4 v10, s[20:23], s39 offen  lds
    s_add_u32 m0, s33, 52224
    s_add_u32 s39, s39, s31
    buffer_load_dwordx4 v9, s[16:19], s38 offen  lds
    s_add_u32 m0, s33, 117760
    s_add_u32 s38, s38, s30
    buffer_load_dwordx4 v11, s[20:23], s39 offen  lds
    s_waitcnt vmcnt(24)
    s_barrier
    s_waitcnt vmcnt(16)
    s_barrier
    s_lshl_b32 s38, s34, 7
    s_add_u32 s38, s38, s28
    s_mul_i32 s39, s34, s32
    s_add_u32 s39, s39, s29
    s_bfe_u32 s34, s35, 262164
    s_xor_b32 s34, s34, s12
    s_add_u32 m0, s33, 0
    s_nop 0
    buffer_load_dwordx4 v8, s[16:19], s38 offen  lds
    s_add_u32 m0, s33, 65536
    s_add_u32 s38, s38, s30
    s_mov_b64 exec, s[36:37]
    buffer_load_dwordx4 v10, s[20:23], s39 offen  lds
    s_mov_b64 exec, -1
    s_add_u32 m0, s33, 1024
    s_add_u32 s39, s39, s31
    buffer_load_dwordx4 v9, s[16:19], s38 offen  lds
    s_add_u32 m0, s33, 66560
    s_add_u32 s38, s38, s30
    buffer_load_dwordx4 v11, s[20:23], s39 offen  lds
    s_add_u32 m0, s33, 2048
    s_add_u32 s39, s39, s31
    buffer_load_dwordx4 v8, s[16:19], s38 offen  lds
    s_add_u32 m0, s33, 67584
    s_add_u32 s38, s38, s30
    buffer_load_dwordx4 v10, s[20:23], s39 offen  lds
    s_add_u32 m0, s33, 3072
    s_add_u32 s39, s39, s31
    buffer_load_dwordx4 v9, s[16:19], s38 offen  lds
    s_add_u32 m0, s33, 68608
    s_add_u32 s38, s38, s30
    buffer_load_dwordx4 v11, s[20:23], s39 offen  lds
    s_waitcnt vmcnt(16)
    s_barrier
    s_lshl_b32 s38, s34, 7
    s_add_u32 s38, s38, s28
    s_mul_i32 s39, s34, s32
    s_add_u32 s39, s39, s29
    s_bfe_u32 s34, s35, 262168
    s_xor_b32 s34, s34, s12
    s_add_u32 m0, s33, 16384
    s_nop 0
    buffer_load_dwordx4 v8, s[16:19], s38 offen  lds
    s_add_u32 m0, s33, 81920
    s_add_u32 s38, s38, s30
    s_mov_b64 exec, s[36:37]
    buffer_load_dwordx4 v10, s[20:23], s39 offen  lds
    s_mov_b64 exec, -1
    s_add_u32 m0, s33, 17408
    s_add_u32 s39, s39, s31
    buffer_load_dwordx4 v9, s[16:19], s38 offen  lds
    s_add_u32 m0, s33, 82944
    s_add_u32 s38, s38, s30
    buffer_load_dwordx4 v11, s[20:23], s39 offen  lds
    s_add_u32 m0, s33, 18432
    s_add_u32 s39, s39, s31
    buffer_load_dwordx4 v8, s[16:19], s38 offen  lds
    s_add_u32 m0, s33, 83968
    s_add_u32 s38, s38, s30
    buffer_load_dwordx4 v10, s[20:23], s39 offen  lds
    s_add_u32 m0, s33, 19456
    s_add_u32 s39, s39, s31
    buffer_load_dwordx4 v9, s[16:19], s38 offen  lds
    s_add_u32 m0, s33, 84992
    s_add_u32 s38, s38, s30
    buffer_load_dwordx4 v11, s[20:23], s39 offen  lds
    s_waitcnt vmcnt(16)
    s_barrier
    s_lshl_b32 s38, s34, 7
    s_add_u32 s38, s38, s28
    s_mul_i32 s39, s34, s32
    s_add_u32 s39, s39, s29
    s_bfe_u32 s34, s35, 262172
    s_xor_b32 s34, s34, s12
    s_add_u32 m0, s33, 32768
    s_nop 0
    buffer_load_dwordx4 v8, s[16:19], s38 offen  lds
    s_add_u32 m0, s33, 98304
    s_add_u32 s38, s38, s30
    s_mov_b64 exec, s[36:37]
    buffer_load_dwordx4 v10, s[20:23], s39 offen  lds
    s_mov_b64 exec, -1
    s_add_u32 m0, s33, 33792
    s_add_u32 s39, s39, s31
    buffer_load_dwordx4 v9, s[16:19], s38 offen  lds
    s_add_u32 m0, s33, 99328
    s_add_u32 s38, s38, s30
    buffer_load_dwordx4 v11, s[20:23], s39 offen  lds
    s_add_u32 m0, s33, 34816
    s_add_u32 s39, s39, s31
    buffer_load_dwordx4 v8, s[16:19], s38 offen  lds
    s_add_u32 m0, s33, 100352
    s_add_u32 s38, s38, s30
    buffer_load_dwordx4 v10, s[20:23], s39 offen  lds
    s_add_u32 m0, s33, 35840
    s_add_u32 s39, s39, s31
    buffer_load_dwordx4 v9, s[16:19], s38 offen  lds
    s_add_u32 m0, s33, 101376
    s_add_u32 s38, s38, s30
    buffer_load_dwordx4 v11, s[20:23], s39 offen  lds
    s_waitcnt vmcnt(16)
    s_barrier
    s_lshl_b32 s38, s34, 7
    s_add_u32 s38, s38, s28
    s_mul_i32 s39, s34, s32
    s_add_u32 s39, s39, s29
    s_bfe_u32 s34, s35, 262144
    s_xor_b32 s34, s34, s12
    s_add_u32 m0, s33, 49152
    s_nop 0
    buffer_load_dwordx4 v8, s[16:19], s38 offen  lds
    s_add_u32 m0, s33, 114688
    s_add_u32 s38, s38, s30
    s_mov_b64 exec, s[36:37]
    buffer_load_dwordx4 v10, s[20:23], s39 offen  lds
    s_mov_b64 exec, -1
    s_add_u32 m0, s33, 50176
    s_add_u32 s39, s39, s31
    buffer_load_dwordx4 v9, s[16:19], s38 offen  lds
    s_add_u32 m0, s33, 115712
    s_add_u32 s38, s38, s30
    buffer_load_dwordx4 v11, s[20:23], s39 offen  lds
    s_add_u32 m0, s33, 51200
    s_add_u32 s39, s39, s31
    buffer_load_dwordx4 v8, s[16:19], s38 offen  lds
    s_add_u32 m0, s33, 116736
    s_add_u32 s38, s38, s30
    buffer_load_dwordx4 v10, s[20:23], s39 offen  lds
    s_add_u32 m0, s33, 52224
    s_add_u32 s39, s39, s31
    buffer_load_dwordx4 v9, s[16:19], s38 offen  lds
    s_add_u32 m0, s33, 117760
    s_add_u32 s38, s38, s30
    buffer_load_dwordx4 v11, s[20:23], s39 offen  lds
    s_waitcnt vmcnt(16)
    s_barrier
    s_branch F_ldpost
F_comp:
    s_and_b32 s58, s2, 7
    s_lshr_b32 s59, s2, 3
    s_lshl_b32 s50, s58, 2
    s_and_b32 s60, s59, 3
    s_add_u32 s50, s50, s60
    s_lshr_b32 s51, s59, 2
    s_and_b32 s53, s58, 3
    s_cmp_ge_u32 s59, 16
    s_cselect_b32 s61, 7, 0
    s_xor_b32 s53, s53, s61
    s_and_b32 s54, s59, 7
    s_lshl_b32 s54, s54, 1
    s_lshr_b32 s61, s58, 2
    s_add_u32 s54, s54, s61
    s_lshr_b32 s60, s59, 2
    s_and_b32 s60, s60, 2
    s_sub_u32 s61, 32, s54
    s_cmp_eq_u32 s54, 0
    s_cselect_b32 s61, 16, s61
    s_cmp_lt_u32 s60, 2
    s_cselect_b32 s52, s54, s61
    s_mov_b32 s14, 0
    s_mov_b64 s[46:47], 0
    s_setprio 2
    v_bfe_u32 v24, v1, 1, 2
    v_bfe_u32 v25, v1, 3, 1
    v_lshl_add_u32 v24, v24, 1, v25
    v_bfe_u32 v24, v1, 1, 3
    v_and_b32 v25, 1, v1
    v_lshl_add_u32 v24, v25, 5, v24
    s_lshl_b32 s58, s8, 3
    s_add_u32 s58, s58, 32
    v_add_u32 v24, s58, v24
    s_lshl_b32 s58, s51, 2
    s_add_u32 s58, s58, s8
    v_mov_b32 v25, s58
    s_mov_b32 vcc_lo, 0xffff0000
    s_mov_b32 vcc_hi, 0
    v_cndmask_b32 v24, v25, v24, vcc
    s_lshr_b32 s58, s50, 2
    s_lshl_b32 s58, s58, 7
    s_add_u32 s58, s58, 14155776
    v_lshl_add_u32 v190, v24, 10, s58
    s_waitcnt lgkmcnt(0)
    s_cmp_lt_u32 s2, 192
    s_cselect_b32 exec_lo, 0xffff, -1
    buffer_load_dwordx2 v[188:189], v190, s[24:27], 0 offen sc1
    s_mov_b32 exec_lo, -1
    s_cmp_lg_u32 s8, 0
    s_cbranch_scc1 F_cp1
    s_cmp_lg_u32 s2, 0
    s_cbranch_scc1 F_cp1
    s_memrealtime s[58:59]
    s_waitcnt lgkmcnt(0)
    s_or_b32 s58, s58, 1
    v_mov_b32 v206, s58
    v_mov_b32 v207, s59
    s_mov_b32 s46, 1
F_cp1:
    s_cmp_eq_u32 s9, 3
    s_cbranch_scc1 F_cf
    s_and_b32 s28, s8, 1
    s_lshr_b32 s29, s8, 1
    v_bfe_u32 v12, v1, 2, 2
    s_lshl_b32 s3, s29, 1
    v_xor_b32 v13, s3, v12
    v_lshlrev_b32 v13, 6, v13
    v_lshl_add_u32 v13, v12, 8, v13
    v_lshl_add_u32 v13, v3, 11, v13
    v_bfe_u32 v14, v1, 4, 1
    v_lshl_add_u32 v13, v14, 5, v13
    v_and_b32 v14, 3, v1
    v_lshl_add_u32 v13, v14, 3, v13
    v_add_u32 v8, 65536, v13
    v_xor_b32 v9, 64, v8
    s_lshl_b32 s3, s28, 6
    s_lshl_b32 s35, s11, 1
    s_add_u32 s35, s35, s29
    s_lshl_b32 s31, s9, 2
    s_add_u32 s31, s31, s11
    s_cmp_lt_u32 s9, 0
    s_cselect_b32 s35, s31, s35
    s_cselect_b32 s9, s29, s9
    s_lshl_b32 s30, s35, 15
    s_lshl_b32 s31, s9, 21
    s_add_u32 s30, s30, s31
    s_and_b32 s31, s10, 3
    s_lshl_b32 s31, s31, 1
    s_lshl_b32 s32, s28, 0
    s_add_u32 s31, s31, s32
    s_lshr_b32 s32, s10, 2
    s_lshr_b32 s15, s31, 1
    s_min_u32 s15, s15, 2
    s_lshr_b32 s33, s10, 1
    s_lshl_b32 s34, s10, 1
    s_and_b32 s34, s34, 2
    s_add_u32 s34, s34, s28
    s_cmp_eq_u32 s9, 0
    s_cselect_b32 s31, s33, s31
    s_cselect_b32 s32, s34, s32
    s_cselect_b32 s15, 0, s15
    s_lshl_b32 s31, s31, 18
    s_lshl_b32 s32, s32, 11
    s_add_u32 s30, s30, s31
    s_add_u32 s36, s30, s32
    s_cmp_eq_u32 s9, 2
    s_cselect_b32 s31, 512, 0
    s_cselect_b32 s32, 0, 0x2000
    s_add_u32 s31, s31, s32
    s_xor_b32 s38, s36, 0x5000
    s_add_u32 s37, s36, s31
    s_add_u32 s39, s38, s31
    s_add_u32 s40, s36, 1024
    s_add_u32 s41, s37, 1024
    s_add_u32 s42, s38, 1024
    s_add_u32 s43, s39, 1024
    s_lshl_b32 s32, s9, 4
    s_add_u32 s32, s32, s10
    s_lshl_b32 s32, s32, 1
    s_add_u32 s32, s32, s28
    s_lshl_b32 s32, s32, 3
    s_add_u32 s32, s32, s35
    s_lshl_b32 s32, s32, 7
    s_add_u32 s14, s32, 14155776
    s_cmp_le_u32 s15, 1
    s_cselect_b64 s[44:45], -1, 0
    s_cmp_lg_u32 s8, 0
    s_cbranch_scc1 F_god
    s_cmp_eq_u32 s15, 0
    s_cbranch_scc1 F_god
    v_mov_b32 v203, 0
    global_load_dwordx2 v[204:205], v203, s[68:69] sc1
    s_mov_b32 s62, 0
F_tagwd_spin:
    s_waitcnt vmcnt(0)
    v_readfirstlane_b32 s48, v204
    v_readfirstlane_b32 s49, v205
    s_cmp_lg_u32 s48, 0
    s_cbranch_scc1 F_tagwd_ok
    v_mov_b32 v203, 0
    global_load_dwordx2 v[204:205], v203, s[68:69] sc1
    s_add_u32 s62, s62, 1
    s_cmp_lt_u32 s62, 262144
    s_cbranch_scc1 F_tagwd_spin
F_tagwd_ok:
F_god:
    s_cmp_eq_u32 s9, 2
    s_cbranch_scc1 F_cv
    v_add_u32 v12, s3, v2
    v_bfe_u32 v13, v12, 1, 3
    v_xor_b32 v13, v13, v3
    v_lshlrev_b32 v13, 4, v13
    v_lshl_add_u32 v4, v12, 7, v13
    v_xor_b32 v5, 32, v4
    v_xor_b32 v6, 64, v4
    v_xor_b32 v7, 96, v4
    v_lshlrev_b32 v176, 4, v1
    s_cmp_eq_u32 s9, 0
    s_cselect_b32 s32, 0x3eb8aa3b, 1.0
    s_mov_b32 s33, s32
    s_barrier
    ds_read_b128 v[16:19], v4 offset:0
    ds_read_b64_tr_b16 v[24:25], v8 offset:0
    ds_read_b64_tr_b16 v[26:27], v8 offset:1024
    ds_read_b64_tr_b16 v[28:29], v9 offset:0
    ds_read_b64_tr_b16 v[30:31], v9 offset:1024
    ds_read_b128 v[20:23], v4 offset:4096
    s_waitcnt lgkmcnt(0)
    v_mfma_f32_32x32x16_bf16 v[64:79], v[24:27], v[16:19], 0
    ds_read_b128 v[32:35], v5 offset:0
    ds_read_b64_tr_b16 v[40:41], v8 offset:4096
    ds_read_b64_tr_b16 v[42:43], v8 offset:5120
    v_mfma_f32_32x32x16_bf16 v[80:95], v[28:31], v[16:19], 0
    ds_read_b64_tr_b16 v[44:45], v9 offset:4096
    ds_read_b64_tr_b16 v[46:47], v9 offset:5120
    ds_read_b128 v[36:39], v5 offset:4096
    v_mfma_f32_32x32x16_bf16 v[96:111], v[24:27], v[20:23], 0
    v_mfma_f32_32x32x16_bf16 v[112:127], v[28:31], v[20:23], 0
    s_waitcnt lgkmcnt(0)
    v_mfma_f32_32x32x16_bf16 v[64:79], v[40:43], v[32:35], v[64:79]
    ds_read_b128 v[16:19], v6 offset:0
    ds_read_b64_tr_b16 v[24:25], v8 offset:8192
    ds_read_b64_tr_b16 v[26:27], v8 offset:9216
    v_mfma_f32_32x32x16_bf16 v[80:95], v[44:47], v[32:35], v[80:95]
    ds_read_b64_tr_b16 v[28:29], v9 offset:8192
    ds_read_b64_tr_b16 v[30:31], v9 offset:9216
    ds_read_b128 v[20:23], v6 offset:4096
    v_mfma_f32_32x32x16_bf16 v[96:111], v[40:43], v[36:39], v[96:111]
    v_mfma_f32_32x32x16_bf16 v[112:127], v[44:47], v[36:39], v[112:127]
    s_waitcnt lgkmcnt(0)
    v_mfma_f32_32x32x16_bf16 v[64:79], v[24:27], v[16:19], v[64:79]
    ds_read_b128 v[32:35], v7 offset:0
    ds_read_b64_tr_b16 v[40:41], v8 offset:12288
    ds_read_b64_tr_b16 v[42:43], v8 offset:13312
    v_mfma_f32_32x32x16_bf16 v[80:95], v[28:31], v[16:19], v[80:95]
    ds_read_b64_tr_b16 v[44:45], v9 offset:12288
    ds_read_b64_tr_b16 v[46:47], v9 offset:13312
    ds_read_b128 v[36:39], v7 offset:4096
    v_mfma_f32_32x32x16_bf16 v[96:111], v[24:27], v[20:23], v[96:111]
    v_mfma_f32_32x32x16_bf16 v[112:127], v[28:31], v[20:23], v[112:127]
    s_waitcnt lgkmcnt(0)
    s_barrier
    v_mfma_f32_32x32x16_bf16 v[64:79], v[40:43], v[32:35], v[64:79]
    ds_read_b128 v[16:19], v4 offset:16384
    ds_read_b64_tr_b16 v[24:25], v8 offset:16384
    ds_read_b64_tr_b16 v[26:27], v8 offset:17408
    v_mfma_f32_32x32x16_bf16 v[80:95], v[44:47], v[32:35], v[80:95]
    ds_read_b64_tr_b16 v[28:29], v9 offset:16384
    ds_read_b64_tr_b16 v[30:31], v9 offset:17408
    ds_read_b128 v[20:23], v4 offset:20480
    v_mfma_f32_32x32x16_bf16 v[96:111], v[40:43], v[36:39], v[96:111]
    v_mfma_f32_32x32x16_bf16 v[112:127], v[44:47], v[36:39], v[112:127]
    s_waitcnt lgkmcnt(0)
    v_mfma_f32_32x32x16_bf16 v[64:79], v[24:27], v[16:19], v[64:79]
    ds_read_b128 v[32:35], v5 offset:16384
    ds_read_b64_tr_b16 v[40:41], v8 offset:20480
    ds_read_b64_tr_b16 v[42:43], v8 offset:21504
    v_mfma_f32_32x32x16_bf16 v[80:95], v[28:31], v[16:19], v[80:95]
    ds_read_b64_tr_b16 v[44:45], v9 offset:20480
    ds_read_b64_tr_b16 v[46:47], v9 offset:21504
    ds_read_b128 v[36:39], v5 offset:20480
    v_mfma_f32_32x32x16_bf16 v[96:111], v[24:27], v[20:23], v[96:111]
    v_mfma_f32_32x32x16_bf16 v[112:127], v[28:31], v[20:23], v[112:127]
    s_waitcnt lgkmcnt(0)
    v_mfma_f32_32x32x16_bf16 v[64:79], v[40:43], v[32:35], v[64:79]
    ds_read_b128 v[16:19], v6 offset:16384
    ds_read_b64_tr_b16 v[24:25], v8 offset:24576
    ds_read_b64_tr_b16 v[26:27], v8 offset:25600
    v_mfma_f32_32x32x16_bf16 v[80:95], v[44:47], v[32:35], v[80:95]
    ds_read_b64_tr_b16 v[28:29], v9 offset:24576
    ds_read_b64_tr_b16 v[30:31], v9 offset:25600
    ds_read_b128 v[20:23], v6 offset:20480
    v_mfma_f32_32x32x16_bf16 v[96:111], v[40:43], v[36:39], v[96:111]
    v_mfma_f32_32x32x16_bf16 v[112:127], v[44:47], v[36:39], v[112:127]
    s_waitcnt lgkmcnt(0)
    v_mfma_f32_32x32x16_bf16 v[64:79], v[24:27], v[16:19], v[64:79]
    ds_read_b128 v[32:35], v7 offset:16384
    ds_read_b64_tr_b16 v[40:41], v8 offset:28672
    ds_read_b64_tr_b16 v[42:43], v8 offset:29696
    v_mfma_f32_32x32x16_bf16 v[80:95], v[28:31], v[16:19], v[80:95]
    ds_read_b64_tr_b16 v[44:45], v9 offset:28672
    ds_read_b64_tr_b16 v[46:47], v9 offset:29696
    ds_read_b128 v[36:39], v7 offset:20480
    v_mfma_f32_32x32x16_bf16 v[96:111], v[24:27], v[20:23], v[96:111]
    v_mfma_f32_32x32x16_bf16 v[112:127], v[28:31], v[20:23], v[112:127]
    s_waitcnt lgkmcnt(0)
    s_barrier
    v_mfma_f32_32x32x16_bf16 v[64:79], v[40:43], v[32:35], v[64:79]
    ds_read_b128 v[16:19], v4 offset:32768
    ds_read_b64_tr_b16 v[24:25], v8 offset:32768
    ds_read_b64_tr_b16 v[26:27], v8 offset:33792
    v_mfma_f32_32x32x16_bf16 v[80:95], v[44:47], v[32:35], v[80:95]
    ds_read_b64_tr_b16 v[28:29], v9 offset:32768
    ds_read_b64_tr_b16 v[30:31], v9 offset:33792
    ds_read_b128 v[20:23], v4 offset:36864
    v_mfma_f32_32x32x16_bf16 v[96:111], v[40:43], v[36:39], v[96:111]
    v_mov_b32 v203, 0
    s_mov_b64 exec, s[46:47]
    global_store_dwordx2 v203, v[206:207], s[68:69] sc1
    s_mov_b64 exec, -1
    v_mfma_f32_32x32x16_bf16 v[112:127], v[44:47], v[36:39], v[112:127]
    s_waitcnt lgkmcnt(0)
    v_mfma_f32_32x32x16_bf16 v[64:79], v[24:27], v[16:19], v[64:79]
    ds_read_b128 v[32:35], v5 offset:32768
    ds_read_b64_tr_b16 v[40:41], v8 offset:36864
    ds_read_b64_tr_b16 v[42:43], v8 offset:37888
    v_mfma_f32_32x32x16_bf16 v[80:95], v[28:31], v[16:19], v[80:95]
    ds_read_b64_tr_b16 v[44:45], v9 offset:36864
    ds_read_b64_tr_b16 v[46:47], v9 offset:37888
    ds_read_b128 v[36:39], v5 offset:36864
    v_mfma_f32_32x32x16_bf16 v[96:111], v[24:27], v[20:23], v[96:111]
    v_mfma_f32_32x32x16_bf16 v[112:127], v[28:31], v[20:23], v[112:127]
    s_waitcnt lgkmcnt(0)
    v_mfma_f32_32x32x16_bf16 v[64:79], v[40:43], v[32:35], v[64:79]
    ds_read_b128 v[16:19], v6 offset:32768
    ds_read_b64_tr_b16 v[24:25], v8 offset:40960
    ds_read_b64_tr_b16 v[26:27], v8 offset:41984
    v_mfma_f32_32x32x16_bf16 v[80:95], v[44:47], v[32:35], v[80:95]
    ds_read_b64_tr_b16 v[28:29], v9 offset:40960
    ds_read_b64_tr_b16 v[30:31], v9 offset:41984
    ds_read_b128 v[20:23], v6 offset:36864
    v_mfma_f32_32x32x16_bf16 v[96:111], v[40:43], v[36:39], v[96:111]
    v_mfma_f32_32x32x16_bf16 v[112:127], v[44:47], v[36:39], v[112:127]
    s_waitcnt lgkmcnt(0)
    v_mfma_f32_32x32x16_bf16 v[64:79], v[24:27], v[16:19], v[64:79]
    ds_read_b128 v[32:35], v7 offset:32768
    ds_read_b64_tr_b16 v[40:41], v8 offset:45056
    ds_read_b64_tr_b16 v[42:43], v8 offset:46080
    v_mfma_f32_32x32x16_bf16 v[80:95], v[28:31], v[16:19], v[80:95]
    ds_read_b64_tr_b16 v[44:45], v9 offset:45056
    ds_read_b64_tr_b16 v[46:47], v9 offset:46080
    ds_read_b128 v[36:39], v7 offset:36864
    v_mfma_f32_32x32x16_bf16 v[96:111], v[24:27], v[20:23], v[96:111]
    v_mfma_f32_32x32x16_bf16 v[112:127], v[28:31], v[20:23], v[112:127]
    s_waitcnt lgkmcnt(0)
    s_barrier
    v_mfma_f32_32x32x16_bf16 v[64:79], v[40:43], v[32:35], v[64:79]
    ds_read_b128 v[16:19], v4 offset:49152
    ds_read_b64_tr_b16 v[24:25], v8 offset:49152
    ds_read_b64_tr_b16 v[26:27], v8 offset:50176
    v_mfma_f32_32x32x16_bf16 v[80:95], v[44:47], v[32:35], v[80:95]
    ds_read_b64_tr_b16 v[28:29], v9 offset:49152
    ds_read_b64_tr_b16 v[30:31], v9 offset:50176
    ds_read_b128 v[20:23], v4 offset:53248
    v_mfma_f32_32x32x16_bf16 v[96:111], v[40:43], v[36:39], v[96:111]
    v_mfma_f32_32x32x16_bf16 v[112:127], v[44:47], v[36:39], v[112:127]
    s_waitcnt lgkmcnt(0)
    v_mfma_f32_32x32x16_bf16 v[64:79], v[24:27], v[16:19], v[64:79]
    ds_read_b128 v[32:35], v5 offset:49152
    ds_read_b64_tr_b16 v[40:41], v8 offset:53248
    ds_read_b64_tr_b16 v[42:43], v8 offset:54272
    v_mfma_f32_32x32x16_bf16 v[80:95], v[28:31], v[16:19], v[80:95]
    ds_read_b64_tr_b16 v[44:45], v9 offset:53248
    ds_read_b64_tr_b16 v[46:47], v9 offset:54272
    ds_read_b128 v[36:39], v5 offset:53248
    v_mfma_f32_32x32x16_bf16 v[96:111], v[24:27], v[20:23], v[96:111]
    v_mfma_f32_32x32x16_bf16 v[112:127], v[28:31], v[20:23], v[112:127]
    s_waitcnt lgkmcnt(0)
    v_mfma_f32_32x32x16_bf16 v[64:79], v[40:43], v[32:35], v[64:79]
    ds_read_b128 v[16:19], v6 offset:49152
    ds_read_b64_tr_b16 v[24:25], v8 offset:57344
    ds_read_b64_tr_b16 v[26:27], v8 offset:58368
    v_mfma_f32_32x32x16_bf16 v[80:95], v[44:47], v[32:35], v[80:95]
    ds_read_b64_tr_b16 v[28:29], v9 offset:57344
    ds_read_b64_tr_b16 v[30:31], v9 offset:58368
    ds_read_b128 v[20:23], v6 offset:53248
    v_mfma_f32_32x32x16_bf16 v[96:111], v[40:43], v[36:39], v[96:111]
    v_mfma_f32_32x32x16_bf16 v[112:127], v[44:47], v[36:39], v[112:127]
    s_waitcnt lgkmcnt(0)
    v_mfma_f32_32x32x16_bf16 v[64:79], v[24:27], v[16:19], v[64:79]
    ds_read_b128 v[32:35], v7 offset:49152
    ds_read_b64_tr_b16 v[40:41], v8 offset:61440
    ds_read_b64_tr_b16 v[42:43], v8 offset:62464
    v_mfma_f32_32x32x16_bf16 v[80:95], v[28:31], v[16:19], v[80:95]
    ds_read_b64_tr_b16 v[44:45], v9 offset:61440
    ds_read_b64_tr_b16 v[46:47], v9 offset:62464
    ds_read_b128 v[36:39], v7 offset:53248
    v_mfma_f32_32x32x16_bf16 v[96:111], v[24:27], v[20:23], v[96:111]
    v_mfma_f32_32x32x16_bf16 v[112:127], v[28:31], v[20:23], v[112:127]
    s_waitcnt lgkmcnt(0)
    s_barrier
    v_mfma_f32_32x32x16_bf16 v[64:79], v[40:43], v[32:35], v[64:79]
    ds_read_b128 v[16:19], v4 offset:0
    ds_read_b64_tr_b16 v[24:25], v8 offset:0
    ds_read_b64_tr_b16 v[26:27], v8 offset:1024
    v_mfma_f32_32x32x16_bf16 v[80:95], v[44:47], v[32:35], v[80:95]
    ds_read_b64_tr_b16 v[28:29], v9 offset:0
    ds_read_b64_tr_b16 v[30:31], v9 offset:1024
    ds_read_b128 v[20:23], v4 offset:4096
    v_mfma_f32_32x32x16_bf16 v[96:111], v[40:43], v[36:39], v[96:111]
    v_mfma_f32_32x32x16_bf16 v[112:127], v[44:47], v[36:39], v[112:127]
    s_waitcnt lgkmcnt(0)
    v_mfma_f32_32x32x16_bf16 v[64:79], v[24:27], v[16:19], v[64:79]
    ds_read_b128 v[32:35], v5 offset:0
    ds_read_b64_tr_b16 v[40:41], v8 offset:4096
    ds_read_b64_tr_b16 v[42:43], v8 offset:5120
    v_mfma_f32_32x32x16_bf16 v[80:95], v[28:31], v[16:19], v[80:95]
    ds_read_b64_tr_b16 v[44:45], v9 offset:4096
    ds_read_b64_tr_b16 v[46:47], v9 offset:5120
    ds_read_b128 v[36:39], v5 offset:4096
    v_mfma_f32_32x32x16_bf16 v[96:111], v[24:27], v[20:23], v[96:111]
    v_mfma_f32_32x32x16_bf16 v[112:127], v[28:31], v[20:23], v[112:127]
    s_waitcnt lgkmcnt(0)
    v_mfma_f32_32x32x16_bf16 v[64:79], v[40:43], v[32:35], v[64:79]
    ds_read_b128 v[16:19], v6 offset:0
    ds_read_b64_tr_b16 v[24:25], v8 offset:8192
    ds_read_b64_tr_b16 v[26:27], v8 offset:9216
    v_mfma_f32_32x32x16_bf16 v[80:95], v[44:47], v[32:35], v[80:95]
    ds_read_b64_tr_b16 v[28:29], v9 offset:8192
    ds_read_b64_tr_b16 v[30:31], v9 offset:9216
    ds_read_b128 v[20:23], v6 offset:4096
    v_mfma_f32_32x32x16_bf16 v[96:111], v[40:43], v[36:39], v[96:111]
    v_mfma_f32_32x32x16_bf16 v[112:127], v[44:47], v[36:39], v[112:127]
    s_waitcnt lgkmcnt(0)
    v_mfma_f32_32x32x16_bf16 v[64:79], v[24:27], v[16:19], v[64:79]
    ds_read_b128 v[32:35], v7 offset:0
    ds_read_b64_tr_b16 v[40:41], v8 offset:12288
    ds_read_b64_tr_b16 v[42:43], v8 offset:13312
    v_mfma_f32_32x32x16_bf16 v[80:95], v[28:31], v[16:19], v[80:95]
    ds_read_b64_tr_b16 v[44:45], v9 offset:12288
    ds_read_b64_tr_b16 v[46:47], v9 offset:13312
    ds_read_b128 v[36:39], v7 offset:4096
    v_mfma_f32_32x32x16_bf16 v[96:111], v[24:27], v[20:23], v[96:111]
    v_mfma_f32_32x32x16_bf16 v[112:127], v[28:31], v[20:23], v[112:127]
    s_waitcnt lgkmcnt(0)
    s_barrier
    v_mfma_f32_32x32x16_bf16 v[64:79], v[40:43], v[32:35], v[64:79]
    ds_read_b128 v[16:19], v4 offset:16384
    ds_read_b64_tr_b16 v[24:25], v8 offset:16384
    ds_read_b64_tr_b16 v[26:27], v8 offset:17408
    v_mfma_f32_32x32x16_bf16 v[80:95], v[44:47], v[32:35], v[80:95]
    ds_read_b64_tr_b16 v[28:29], v9 offset:16384
    ds_read_b64_tr_b16 v[30:31], v9 offset:17408
    ds_read_b128 v[20:23], v4 offset:20480
    v_mfma_f32_32x32x16_bf16 v[96:111], v[40:43], v[36:39], v[96:111]
    v_mfma_f32_32x32x16_bf16 v[112:127], v[44:47], v[36:39], v[112:127]
    s_waitcnt lgkmcnt(0)
    v_mfma_f32_32x32x16_bf16 v[64:79], v[24:27], v[16:19], v[64:79]
    ds_read_b128 v[32:35], v5 offset:16384
    ds_read_b64_tr_b16 v[40:41], v8 offset:20480
    ds_read_b64_tr_b16 v[42:43], v8 offset:21504
    v_mfma_f32_32x32x16_bf16 v[80:95], v[28:31], v[16:19], v[80:95]
    ds_read_b64_tr_b16 v[44:45], v9 offset:20480
    ds_read_b64_tr_b16 v[46:47], v9 offset:21504
    ds_read_b128 v[36:39], v5 offset:20480
    v_mfma_f32_32x32x16_bf16 v[96:111], v[24:27], v[20:23], v[96:111]
    v_mov_b32 v203, 0
    global_load_dwordx2 v[204:205], v203, s[68:69] sc1
    v_mfma_f32_32x32x16_bf16 v[112:127], v[28:31], v[20:23], v[112:127]
    s_waitcnt lgkmcnt(0)
    v_mfma_f32_32x32x16_bf16 v[64:79], v[40:43], v[32:35], v[64:79]
    ds_read_b128 v[16:19], v6 offset:16384
    ds_read_b64_tr_b16 v[24:25], v8 offset:24576
    ds_read_b64_tr_b16 v[26:27], v8 offset:25600
    v_mfma_f32_32x32x16_bf16 v[80:95], v[44:47], v[32:35], v[80:95]
    ds_read_b64_tr_b16 v[28:29], v9 offset:24576
    ds_read_b64_tr_b16 v[30:31], v9 offset:25600
    ds_read_b128 v[20:23], v6 offset:20480
    v_mfma_f32_32x32x16_bf16 v[96:111], v[40:43], v[36:39], v[96:111]
    v_mfma_f32_32x32x16_bf16 v[112:127], v[44:47], v[36:39], v[112:127]
    s_waitcnt lgkmcnt(0)
    v_mfma_f32_32x32x16_bf16 v[64:79], v[24:27], v[16:19], v[64:79]
    ds_read_b128 v[32:35], v7 offset:16384
    ds_read_b64_tr_b16 v[40:41], v8 offset:28672
    ds_read_b64_tr_b16 v[42:43], v8 offset:29696
    v_mfma_f32_32x32x16_bf16 v[80:95], v[28:31], v[16:19], v[80:95]
    ds_read_b64_tr_b16 v[44:45], v9 offset:28672
    ds_read_b64_tr_b16 v[46:47], v9 offset:29696
    ds_read_b128 v[36:39], v7 offset:20480
    v_mfma_f32_32x32x16_bf16 v[96:111], v[24:27], v[20:23], v[96:111]
    v_mfma_f32_32x32x16_bf16 v[112:127], v[28:31], v[20:23], v[112:127]
    s_waitcnt lgkmcnt(0)
    s_barrier
    v_mfma_f32_32x32x16_bf16 v[64:79], v[40:43], v[32:35], v[64:79]
    ds_read_b128 v[16:19], v4 offset:32768
    ds_read_b64_tr_b16 v[24:25], v8 offset:32768
    ds_read_b64_tr_b16 v[26:27], v8 offset:33792
    v_mfma_f32_32x32x16_bf16 v[80:95], v[44:47], v[32:35], v[80:95]
    ds_read_b64_tr_b16 v[28:29], v9 offset:32768
    ds_read_b64_tr_b16 v[30:31], v9 offset:33792
    ds_read_b128 v[20:23], v4 offset:36864
    v_mfma_f32_32x32x16_bf16 v[96:111], v[40:43], v[36:39], v[96:111]
    v_mfma_f32_32x32x16_bf16 v[112:127], v[44:47], v[36:39], v[112:127]
    s_waitcnt lgkmcnt(0)
    v_mfma_f32_32x32x16_bf16 v[64:79], v[24:27], v[16:19], v[64:79]
    ds_read_b128 v[32:35], v5 offset:32768
    ds_read_b64_tr_b16 v[40:41], v8 offset:36864
    ds_read_b64_tr_b16 v[42:43], v8 offset:37888
    v_mfma_f32_32x32x16_bf16 v[80:95], v[28:31], v[16:19], v[80:95]
    ds_read_b64_tr_b16 v[44:45], v9 offset:36864
    ds_read_b64_tr_b16 v[46:47], v9 offset:37888
    ds_read_b128 v[36:39], v5 offset:36864
    v_mfma_f32_32x32x16_bf16 v[96:111], v[24:27], v[20:23], v[96:111]
    v_mfma_f32_32x32x16_bf16 v[112:127], v[28:31], v[20:23], v[112:127]
    s_waitcnt lgkmcnt(0)
    v_mfma_f32_32x32x16_bf16 v[64:79], v[40:43], v[32:35], v[64:79]
    ds_read_b128 v[16:19], v6 offset:32768
    ds_read_b64_tr_b16 v[24:25], v8 offset:40960
    ds_read_b64_tr_b16 v[26:27], v8 offset:41984
    v_mfma_f32_32x32x16_bf16 v[80:95], v[44:47], v[32:35], v[80:95]
    ds_read_b64_tr_b16 v[28:29], v9 offset:40960
    ds_read_b64_tr_b16 v[30:31], v9 offset:41984
    ds_read_b128 v[20:23], v6 offset:36864
    v_mfma_f32_32x32x16_bf16 v[96:111], v[40:43], v[36:39], v[96:111]
    v_mfma_f32_32x32x16_bf16 v[112:127], v[44:47], v[36:39], v[112:127]
    s_waitcnt lgkmcnt(0)
    v_mfma_f32_32x32x16_bf16 v[64:79], v[24:27], v[16:19], v[64:79]
    ds_read_b128 v[32:35], v7 offset:32768
    ds_read_b64_tr_b16 v[40:41], v8 offset:45056
    ds_read_b64_tr_b16 v[42:43], v8 offset:46080
    v_mfma_f32_32x32x16_bf16 v[80:95], v[28:31], v[16:19], v[80:95]
    ds_read_b64_tr_b16 v[44:45], v9 offset:45056
    ds_read_b64_tr_b16 v[46:47], v9 offset:46080
    ds_read_b128 v[36:39], v7 offset:36864
    v_mfma_f32_32x32x16_bf16 v[96:111], v[24:27], v[20:23], v[96:111]
    s_mov_b32 s62, 0
F_tagqk_spin:
    s_waitcnt vmcnt(0)
    v_readfirstlane_b32 s48, v204
    v_readfirstlane_b32 s49, v205
    s_cmp_lg_u32 s48, 0
    s_cbranch_scc1 F_tagqk_ok
    v_mov_b32 v203, 0
    global_load_dwordx2 v[204:205], v203, s[68:69] sc1
    s_add_u32 s62, s62, 1
    s_cmp_lt_u32 s62, 262144
    s_cbranch_scc1 F_tagqk_spin
F_tagqk_ok:
    v_mov_b32 v188, s48
    v_mov_b32 v189, s49
    v_lshlrev_b32 v190, 3, v1
    v_mfma_f32_32x32x16_bf16 v[112:127], v[28:31], v[20:23], v[112:127]
    s_waitcnt lgkmcnt(0)
    s_barrier
    v_mfma_f32_32x32x16_bf16 v[64:79], v[40:43], v[32:35], v[64:79]
    ds_read_b128 v[16:19], v4 offset:49152
    ds_read_b64_tr_b16 v[24:25], v8 offset:49152
    ds_read_b64_tr_b16 v[26:27], v8 offset:50176
    v_mfma_f32_32x32x16_bf16 v[80:95], v[44:47], v[32:35], v[80:95]
    ds_read_b64_tr_b16 v[28:29], v9 offset:49152
    ds_read_b64_tr_b16 v[30:31], v9 offset:50176
    ds_read_b128 v[48:51], v5 offset:49152
    v_mfma_f32_32x32x16_bf16 v[96:111], v[40:43], v[36:39], v[96:111]
    ds_read_b64_tr_b16 v[56:57], v8 offset:53248
    ds_read_b64_tr_b16 v[58:59], v8 offset:54272
    v_mfma_f32_32x32x16_bf16 v[112:127], v[44:47], v[36:39], v[112:127]
    ds_read_b64_tr_b16 v[60:61], v9 offset:53248
    ds_read_b64_tr_b16 v[62:63], v9 offset:54272
    s_waitcnt lgkmcnt(5)
    v_mfma_f32_32x32x16_bf16 v[64:79], v[24:27], v[16:19], v[64:79]
    ds_read_b128 v[128:131], v6 offset:49152
    ds_read_b64_tr_b16 v[136:137], v8 offset:57344
    ds_read_b64_tr_b16 v[138:139], v8 offset:58368
    v_mfma_f32_32x32x16_bf16 v[80:95], v[28:31], v[16:19], v[80:95]
    ds_read_b64_tr_b16 v[140:141], v9 offset:57344
    ds_read_b64_tr_b16 v[142:143], v9 offset:58368
    s_waitcnt lgkmcnt(5)
    v_mfma_f32_32x32x16_bf16 v[64:79], v[56:59], v[48:51], v[64:79]
    ds_read_b128 v[32:35], v7 offset:49152
    ds_read_b64_tr_b16 v[40:41], v8 offset:61440
    ds_read_b64_tr_b16 v[42:43], v8 offset:62464
    v_mfma_f32_32x32x16_bf16 v[80:95], v[60:63], v[48:51], v[80:95]
    ds_read_b64_tr_b16 v[44:45], v9 offset:61440
    ds_read_b64_tr_b16 v[46:47], v9 offset:62464
    s_waitcnt lgkmcnt(5)
    v_mfma_f32_32x32x16_bf16 v[64:79], v[136:139], v[128:131], v[64:79]
    ds_read_b128 v[20:23], v4 offset:53248
    ds_read_b128 v[52:55], v5 offset:53248
    v_mfma_f32_32x32x16_bf16 v[80:95], v[140:143], v[128:131], v[80:95]
    ds_read_b128 v[132:135], v6 offset:53248
    ds_read_b128 v[36:39], v7 offset:53248
    s_waitcnt lgkmcnt(4)
    v_mfma_f32_32x32x16_bf16 v[64:79], v[40:43], v[32:35], v[64:79]
    v_mfma_f32_32x32x16_bf16 v[80:95], v[44:47], v[32:35], v[80:95]
    s_waitcnt lgkmcnt(0)
    v_mfma_f32_32x32x16_bf16 v[96:111], v[24:27], v[20:23], v[96:111]
    s_nop 6
    v_mfma_f32_32x32x16_bf16 v[112:127], v[28:31], v[20:23], v[112:127]
    v_pk_mul_f32 v[64:65], v[64:65], s[32:33]
    v_pk_mul_f32 v[66:67], v[66:67], s[32:33]
    v_pk_mul_f32 v[68:69], v[68:69], s[32:33]
    v_pk_mul_f32 v[70:71], v[70:71], s[32:33]
    v_cvt_pk_bf16_f32 v144, v64, v65
    v_mfma_f32_32x32x16_bf16 v[96:111], v[56:59], v[52:55], v[96:111]
    v_cvt_pk_bf16_f32 v145, v66, v67
    v_cvt_pk_bf16_f32 v146, v68, v69
    v_cvt_pk_bf16_f32 v147, v70, v71
    s_mov_b64 exec, s[44:45]
    buffer_store_dwordx4 v[144:147], v176, s[24:27], s36 offen sc1
    s_mov_b64 exec, -1
    v_pk_mul_f32 v[72:73], v[72:73], s[32:33]
    v_mfma_f32_32x32x16_bf16 v[112:127], v[60:63], v[52:55], v[112:127]
    v_pk_mul_f32 v[74:75], v[74:75], s[32:33]
    v_pk_mul_f32 v[76:77], v[76:77], s[32:33]
    v_pk_mul_f32 v[78:79], v[78:79], s[32:33]
    v_cvt_pk_bf16_f32 v148, v72, v73
    v_cvt_pk_bf16_f32 v149, v74, v75
    v_mfma_f32_32x32x16_bf16 v[96:111], v[136:139], v[132:135], v[96:111]
    v_cvt_pk_bf16_f32 v150, v76, v77
    v_cvt_pk_bf16_f32 v151, v78, v79
    s_mov_b64 exec, s[44:45]
    buffer_store_dwordx4 v[148:151], v176, s[24:27], s37 offen sc1
    s_mov_b64 exec, -1
    v_pk_mul_f32 v[80:81], v[80:81], s[32:33]
    v_pk_mul_f32 v[82:83], v[82:83], s[32:33]
    v_pk_mul_f32 v[84:85], v[84:85], s[32:33]
    v_mfma_f32_32x32x16_bf16 v[112:127], v[140:143], v[132:135], v[112:127]
    v_pk_mul_f32 v[86:87], v[86:87], s[32:33]
    v_cvt_pk_bf16_f32 v152, v80, v81
    v_cvt_pk_bf16_f32 v153, v82, v83
    v_cvt_pk_bf16_f32 v154, v84, v85
    v_cvt_pk_bf16_f32 v155, v86, v87
    v_mfma_f32_32x32x16_bf16 v[96:111], v[40:43], v[36:39], v[96:111]
    s_mov_b64 exec, s[44:45]
    buffer_store_dwordx4 v[152:155], v176, s[24:27], s38 offen sc1
    s_mov_b64 exec, -1
    v_pk_mul_f32 v[88:89], v[88:89], s[32:33]
    v_pk_mul_f32 v[90:91], v[90:91], s[32:33]
    v_pk_mul_f32 v[92:93], v[92:93], s[32:33]
    v_pk_mul_f32 v[94:95], v[94:95], s[32:33]
    v_mfma_f32_32x32x16_bf16 v[112:127], v[44:47], v[36:39], v[112:127]
    v_cvt_pk_bf16_f32 v156, v88, v89
    v_cvt_pk_bf16_f32 v157, v90, v91
    v_cvt_pk_bf16_f32 v158, v92, v93
    v_cvt_pk_bf16_f32 v159, v94, v95
    s_mov_b64 exec, s[44:45]
    buffer_store_dwordx4 v[156:159], v176, s[24:27], s39 offen sc1
    s_mov_b64 exec, -1
    s_cmp_le_u32 s15, 1
    s_nop 0
    s_cbranch_scc0 F_epi_late
    v_pk_mul_f32 v[96:97], v[96:97], s[32:33]
    v_pk_mul_f32 v[98:99], v[98:99], s[32:33]
    v_pk_mul_f32 v[100:101], v[100:101], s[32:33]
    v_pk_mul_f32 v[102:103], v[102:103], s[32:33]
    v_cvt_pk_bf16_f32 v160, v96, v97
    v_cvt_pk_bf16_f32 v161, v98, v99
    v_cvt_pk_bf16_f32 v162, v100, v101
    v_cvt_pk_bf16_f32 v163, v102, v103
    buffer_store_dwordx4 v[160:163], v176, s[24:27], s40 offen sc1
    v_pk_mul_f32 v[104:105], v[104:105], s[32:33]
    v_pk_mul_f32 v[106:107], v[106:107], s[32:33]
    v_pk_mul_f32 v[108:109], v[108:109], s[32:33]
    v_pk_mul_f32 v[110:111], v[110:111], s[32:33]
    v_cvt_pk_bf16_f32 v164, v104, v105
    v_cvt_pk_bf16_f32 v165, v106, v107
    v_cvt_pk_bf16_f32 v166, v108, v109
    v_cvt_pk_bf16_f32 v167, v110, v111
    buffer_store_dwordx4 v[164:167], v176, s[24:27], s41 offen sc1
    v_pk_mul_f32 v[112:113], v[112:113], s[32:33]
    v_pk_mul_f32 v[114:115], v[114:115], s[32:33]
    v_pk_mul_f32 v[116:117], v[116:117], s[32:33]
    v_pk_mul_f32 v[118:119], v[118:119], s[32:33]
    v_cvt_pk_bf16_f32 v168, v112, v113
    v_cvt_pk_bf16_f32 v169, v114, v115
    v_cvt_pk_bf16_f32 v170, v116, v117
    v_cvt_pk_bf16_f32 v171, v118, v119
    buffer_store_dwordx4 v[168:171], v176, s[24:27], s42 offen sc1
    v_pk_mul_f32 v[120:121], v[120:121], s[32:33]
    v_pk_mul_f32 v[122:123], v[122:123], s[32:33]
    v_pk_mul_f32 v[124:125], v[124:125], s[32:33]
    v_pk_mul_f32 v[126:127], v[126:127], s[32:33]
    v_cvt_pk_bf16_f32 v172, v120, v121
    v_cvt_pk_bf16_f32 v173, v122, v123
    v_cvt_pk_bf16_f32 v174, v124, v125
    v_cvt_pk_bf16_f32 v175, v126, v127
    buffer_store_dwordx4 v[172:175], v176, s[24:27], s43 offen sc1
    s_cmp_lg_u32 s15, 0
    s_cbranch_scc1 F_p1done
    s_mov_b64 exec, 65535
    s_waitcnt vmcnt(0)
    buffer_store_dwordx2 v[188:189], v190, s[24:27], s14 offen sc1
    s_mov_b64 exec, -1
    s_barrier
    s_branch F_p1done
F_cv:
    v_and_b32 v12, 0x13, v2
    v_bfe_u32 v13, v2, 2, 1
    v_lshl_add_u32 v12, v13, 3, v12
    v_bfe_u32 v13, v2, 3, 1
    v_lshl_add_u32 v12, v13, 2, v12
    v_add_u32 v12, s3, v12
    v_bfe_u32 v13, v12, 1, 3
    v_xor_b32 v13, v13, v3
    v_lshlrev_b32 v13, 4, v13
    v_lshl_add_u32 v4, v12, 7, v13
    v_xor_b32 v5, 32, v4
    v_xor_b32 v6, 64, v4
    v_xor_b32 v7, 96, v4
    v_and_b32 v10, 15, v1
    v_lshlrev_b32 v10, 4, v10
    v_lshl_add_u32 v10, v3, 8, v10
    v_bfe_u32 v13, v1, 4, 1
    v_lshl_add_u32 v176, v13, 13, v10
    s_mov_b32 s32, 0x4f800000
    s_mov_b32 s33, s32
    s_barrier
    ds_read_b128 v[16:19], v4 offset:0
    ds_read_b64_tr_b16 v[24:25], v8 offset:0
    ds_read_b64_tr_b16 v[26:27], v8 offset:1024
    ds_read_b64_tr_b16 v[28:29], v9 offset:0
    ds_read_b64_tr_b16 v[30:31], v9 offset:1024
    ds_read_b128 v[20:23], v4 offset:4096
    s_waitcnt lgkmcnt(0)
    v_mfma_f32_32x32x16_bf16 v[64:79], v[16:19], v[24:27], 0
    ds_read_b128 v[32:35], v5 offset:0
    ds_read_b64_tr_b16 v[40:41], v8 offset:4096
    ds_read_b64_tr_b16 v[42:43], v8 offset:5120
    v_mfma_f32_32x32x16_bf16 v[80:95], v[16:19], v[28:31], 0
    ds_read_b64_tr_b16 v[44:45], v9 offset:4096
    ds_read_b64_tr_b16 v[46:47], v9 offset:5120
    ds_read_b128 v[36:39], v5 offset:4096
    v_mfma_f32_32x32x16_bf16 v[96:111], v[20:23], v[24:27], 0
    v_mfma_f32_32x32x16_bf16 v[112:127], v[20:23], v[28:31], 0
    s_waitcnt lgkmcnt(0)
    v_mfma_f32_32x32x16_bf16 v[64:79], v[32:35], v[40:43], v[64:79]
    ds_read_b128 v[16:19], v6 offset:0
    ds_read_b64_tr_b16 v[24:25], v8 offset:8192
    ds_read_b64_tr_b16 v[26:27], v8 offset:9216
    v_mfma_f32_32x32x16_bf16 v[80:95], v[32:35], v[44:47], v[80:95]
    ds_read_b64_tr_b16 v[28:29], v9 offset:8192
    ds_read_b64_tr_b16 v[30:31], v9 offset:9216
    ds_read_b128 v[20:23], v6 offset:4096
    v_mfma_f32_32x32x16_bf16 v[96:111], v[36:39], v[40:43], v[96:111]
    v_mfma_f32_32x32x16_bf16 v[112:127], v[36:39], v[44:47], v[112:127]
    s_waitcnt lgkmcnt(0)
    v_mfma_f32_32x32x16_bf16 v[64:79], v[16:19], v[24:27], v[64:79]
    ds_read_b128 v[32:35], v7 offset:0
    ds_read_b64_tr_b16 v[40:41], v8 offset:12288
    ds_read_b64_tr_b16 v[42:43], v8 offset:13312
    v_mfma_f32_32x32x16_bf16 v[80:95], v[16:19], v[28:31], v[80:95]
    ds_read_b64_tr_b16 v[44:45], v9 offset:12288
    ds_read_b64_tr_b16 v[46:47], v9 offset:13312
    ds_read_b128 v[36:39], v7 offset:4096
    v_mfma_f32_32x32x16_bf16 v[96:111], v[20:23], v[24:27], v[96:111]
    v_mfma_f32_32x32x16_bf16 v[112:127], v[20:23], v[28:31], v[112:127]
    s_waitcnt lgkmcnt(0)
    s_barrier
    v_mfma_f32_32x32x16_bf16 v[64:79], v[32:35], v[40:43], v[64:79]
    ds_read_b128 v[16:19], v4 offset:16384
    ds_read_b64_tr_b16 v[24:25], v8 offset:16384
    ds_read_b64_tr_b16 v[26:27], v8 offset:17408
    v_mfma_f32_32x32x16_bf16 v[80:95], v[32:35], v[44:47], v[80:95]
    ds_read_b64_tr_b16 v[28:29], v9 offset:16384
    ds_read_b64_tr_b16 v[30:31], v9 offset:17408
    ds_read_b128 v[20:23], v4 offset:20480
    v_mfma_f32_32x32x16_bf16 v[96:111], v[36:39], v[40:43], v[96:111]
    v_mfma_f32_32x32x16_bf16 v[112:127], v[36:39], v[44:47], v[112:127]
    s_waitcnt lgkmcnt(0)
    v_mfma_f32_32x32x16_bf16 v[64:79], v[16:19], v[24:27], v[64:79]
    ds_read_b128 v[32:35], v5 offset:16384
    ds_read_b64_tr_b16 v[40:41], v8 offset:20480
    ds_read_b64_tr_b16 v[42:43], v8 offset:21504
    v_mfma_f32_32x32x16_bf16 v[80:95], v[16:19], v[28:31], v[80:95]
    ds_read_b64_tr_b16 v[44:45], v9 offset:20480
    ds_read_b64_tr_b16 v[46:47], v9 offset:21504
    ds_read_b128 v[36:39], v5 offset:20480
    v_mfma_f32_32x32x16_bf16 v[96:111], v[20:23], v[24:27], v[96:111]
    v_mfma_f32_32x32x16_bf16 v[112:127], v[20:23], v[28:31], v[112:127]
    s_waitcnt lgkmcnt(0)
    v_mfma_f32_32x32x16_bf16 v[64:79], v[32:35], v[40:43], v[64:79]
    ds_read_b128 v[16:19], v6 offset:16384
    ds_read_b64_tr_b16 v[24:25], v8 offset:24576
    ds_read_b64_tr_b16 v[26:27], v8 offset:25600
    v_mfma_f32_32x32x16_bf16 v[80:95], v[32:35], v[44:47], v[80:95]
    ds_read_b64_tr_b16 v[28:29], v9 offset:24576
    ds_read_b64_tr_b16 v[30:31], v9 offset:25600
    ds_read_b128 v[20:23], v6 offset:20480
    v_mfma_f32_32x32x16_bf16 v[96:111], v[36:39], v[40:43], v[96:111]
    v_mfma_f32_32x32x16_bf16 v[112:127], v[36:39], v[44:47], v[112:127]
    s_waitcnt lgkmcnt(0)
    v_mfma_f32_32x32x16_bf16 v[64:79], v[16:19], v[24:27], v[64:79]
    ds_read_b128 v[32:35], v7 offset:16384
    ds_read_b64_tr_b16 v[40:41], v8 offset:28672
    ds_read_b64_tr_b16 v[42:43], v8 offset:29696
    v_mfma_f32_32x32x16_bf16 v[80:95], v[16:19], v[28:31], v[80:95]
    ds_read_b64_tr_b16 v[44:45], v9 offset:28672
    ds_read_b64_tr_b16 v[46:47], v9 offset:29696
    ds_read_b128 v[36:39], v7 offset:20480
    v_mfma_f32_32x32x16_bf16 v[96:111], v[20:23], v[24:27], v[96:111]
    v_mfma_f32_32x32x16_bf16 v[112:127], v[20:23], v[28:31], v[112:127]
    s_waitcnt lgkmcnt(0)
    s_barrier
    v_mfma_f32_32x32x16_bf16 v[64:79], v[32:35], v[40:43], v[64:79]
    ds_read_b128 v[16:19], v4 offset:32768
    ds_read_b64_tr_b16 v[24:25], v8 offset:32768
    ds_read_b64_tr_b16 v[26:27], v8 offset:33792
    v_mfma_f32_32x32x16_bf16 v[80:95], v[32:35], v[44:47], v[80:95]
    ds_read_b64_tr_b16 v[28:29], v9 offset:32768
    ds_read_b64_tr_b16 v[30:31], v9 offset:33792
    ds_read_b128 v[20:23], v4 offset:36864
    v_mfma_f32_32x32x16_bf16 v[96:111], v[36:39], v[40:43], v[96:111]
    v_mfma_f32_32x32x16_bf16 v[112:127], v[36:39], v[44:47], v[112:127]
    s_waitcnt lgkmcnt(0)
    v_mfma_f32_32x32x16_bf16 v[64:79], v[16:19], v[24:27], v[64:79]
    ds_read_b128 v[32:35], v5 offset:32768
    ds_read_b64_tr_b16 v[40:41], v8 offset:36864
    ds_read_b64_tr_b16 v[42:43], v8 offset:37888
    v_mfma_f32_32x32x16_bf16 v[80:95], v[16:19], v[28:31], v[80:95]
    ds_read_b64_tr_b16 v[44:45], v9 offset:36864
    ds_read_b64_tr_b16 v[46:47], v9 offset:37888
    ds_read_b128 v[36:39], v5 offset:36864
    v_mfma_f32_32x32x16_bf16 v[96:111], v[20:23], v[24:27], v[96:111]
    v_mfma_f32_32x32x16_bf16 v[112:127], v[20:23], v[28:31], v[112:127]
    s_waitcnt lgkmcnt(0)
    v_mfma_f32_32x32x16_bf16 v[64:79], v[32:35], v[40:43], v[64:79]
    ds_read_b128 v[16:19], v6 offset:32768
    ds_read_b64_tr_b16 v[24:25], v8 offset:40960
    ds_read_b64_tr_b16 v[26:27], v8 offset:41984
    v_mfma_f32_32x32x16_bf16 v[80:95], v[32:35], v[44:47], v[80:95]
    ds_read_b64_tr_b16 v[28:29], v9 offset:40960
    ds_read_b64_tr_b16 v[30:31], v9 offset:41984
    ds_read_b128 v[20:23], v6 offset:36864
    v_mfma_f32_32x32x16_bf16 v[96:111], v[36:39], v[40:43], v[96:111]
    v_mfma_f32_32x32x16_bf16 v[112:127], v[36:39], v[44:47], v[112:127]
    s_waitcnt lgkmcnt(0)
    v_mfma_f32_32x32x16_bf16 v[64:79], v[16:19], v[24:27], v[64:79]
    ds_read_b128 v[32:35], v7 offset:32768
    ds_read_b64_tr_b16 v[40:41], v8 offset:45056
    ds_read_b64_tr_b16 v[42:43], v8 offset:46080
    v_mfma_f32_32x32x16_bf16 v[80:95], v[16:19], v[28:31], v[80:95]
    ds_read_b64_tr_b16 v[44:45], v9 offset:45056
    ds_read_b64_tr_b16 v[46:47], v9 offset:46080
    ds_read_b128 v[36:39], v7 offset:36864
    v_mfma_f32_32x32x16_bf16 v[96:111], v[20:23], v[24:27], v[96:111]
    v_mfma_f32_32x32x16_bf16 v[112:127], v[20:23], v[28:31], v[112:127]
    s_waitcnt lgkmcnt(0)
    s_barrier
    v_mfma_f32_32x32x16_bf16 v[64:79], v[32:35], v[40:43], v[64:79]
    ds_read_b128 v[16:19], v4 offset:49152
    ds_read_b64_tr_b16 v[24:25], v8 offset:49152
    ds_read_b64_tr_b16 v[26:27], v8 offset:50176
    v_mfma_f32_32x32x16_bf16 v[80:95], v[32:35], v[44:47], v[80:95]
    ds_read_b64_tr_b16 v[28:29], v9 offset:49152
    ds_read_b64_tr_b16 v[30:31], v9 offset:50176
    ds_read_b128 v[20:23], v4 offset:53248
    v_mfma_f32_32x32x16_bf16 v[96:111], v[36:39], v[40:43], v[96:111]
    v_mfma_f32_32x32x16_bf16 v[112:127], v[36:39], v[44:47], v[112:127]
    s_waitcnt lgkmcnt(0)
    v_mfma_f32_32x32x16_bf16 v[64:79], v[16:19], v[24:27], v[64:79]
    ds_read_b128 v[32:35], v5 offset:49152
    ds_read_b64_tr_b16 v[40:41], v8 offset:53248
    ds_read_b64_tr_b16 v[42:43], v8 offset:54272
    v_mfma_f32_32x32x16_bf16 v[80:95], v[16:19], v[28:31], v[80:95]
    ds_read_b64_tr_b16 v[44:45], v9 offset:53248
    ds_read_b64_tr_b16 v[46:47], v9 offset:54272
    ds_read_b128 v[36:39], v5 offset:53248
    v_mfma_f32_32x32x16_bf16 v[96:111], v[20:23], v[24:27], v[96:111]
    v_mfma_f32_32x32x16_bf16 v[112:127], v[20:23], v[28:31], v[112:127]
    s_waitcnt lgkmcnt(0)
    v_mfma_f32_32x32x16_bf16 v[64:79], v[32:35], v[40:43], v[64:79]
    ds_read_b128 v[16:19], v6 offset:49152
    ds_read_b64_tr_b16 v[24:25], v8 offset:57344
    ds_read_b64_tr_b16 v[26:27], v8 offset:58368
    v_mfma_f32_32x32x16_bf16 v[80:95], v[32:35], v[44:47], v[80:95]
    ds_read_b64_tr_b16 v[28:29], v9 offset:57344
    ds_read_b64_tr_b16 v[30:31], v9 offset:58368
    ds_read_b128 v[20:23], v6 offset:53248
    v_mfma_f32_32x32x16_bf16 v[96:111], v[36:39], v[40:43], v[96:111]
    v_mfma_f32_32x32x16_bf16 v[112:127], v[36:39], v[44:47], v[112:127]
    s_waitcnt lgkmcnt(0)
    v_mfma_f32_32x32x16_bf16 v[64:79], v[16:19], v[24:27], v[64:79]
    ds_read_b128 v[32:35], v7 offset:49152
    ds_read_b64_tr_b16 v[40:41], v8 offset:61440
    ds_read_b64_tr_b16 v[42:43], v8 offset:62464
    v_mfma_f32_32x32x16_bf16 v[80:95], v[16:19], v[28:31], v[80:95]
    ds_read_b64_tr_b16 v[44:45], v9 offset:61440
    ds_read_b64_tr_b16 v[46:47], v9 offset:62464
    ds_read_b128 v[36:39], v7 offset:53248
    v_mfma_f32_32x32x16_bf16 v[96:111], v[20:23], v[24:27], v[96:111]
    v_mfma_f32_32x32x16_bf16 v[112:127], v[20:23], v[28:31], v[112:127]
    s_waitcnt lgkmcnt(0)
    s_barrier
    v_mfma_f32_32x32x16_bf16 v[64:79], v[32:35], v[40:43], v[64:79]
    ds_read_b128 v[16:19], v4 offset:0
    ds_read_b64_tr_b16 v[24:25], v8 offset:0
    ds_read_b64_tr_b16 v[26:27], v8 offset:1024
    v_mfma_f32_32x32x16_bf16 v[80:95], v[32:35], v[44:47], v[80:95]
    ds_read_b64_tr_b16 v[28:29], v9 offset:0
    ds_read_b64_tr_b16 v[30:31], v9 offset:1024
    ds_read_b128 v[20:23], v4 offset:4096
    v_mfma_f32_32x32x16_bf16 v[96:111], v[36:39], v[40:43], v[96:111]
    v_mfma_f32_32x32x16_bf16 v[112:127], v[36:39], v[44:47], v[112:127]
    s_waitcnt lgkmcnt(0)
    v_mfma_f32_32x32x16_bf16 v[64:79], v[16:19], v[24:27], v[64:79]
    ds_read_b128 v[32:35], v5 offset:0
    ds_read_b64_tr_b16 v[40:41], v8 offset:4096
    ds_read_b64_tr_b16 v[42:43], v8 offset:5120
    v_mfma_f32_32x32x16_bf16 v[80:95], v[16:19], v[28:31], v[80:95]
    ds_read_b64_tr_b16 v[44:45], v9 offset:4096
    ds_read_b64_tr_b16 v[46:47], v9 offset:5120
    ds_read_b128 v[36:39], v5 offset:4096
    v_mfma_f32_32x32x16_bf16 v[96:111], v[20:23], v[24:27], v[96:111]
    v_mfma_f32_32x32x16_bf16 v[112:127], v[20:23], v[28:31], v[112:127]
    s_waitcnt lgkmcnt(0)
    v_mfma_f32_32x32x16_bf16 v[64:79], v[32:35], v[40:43], v[64:79]
    ds_read_b128 v[16:19], v6 offset:0
    ds_read_b64_tr_b16 v[24:25], v8 offset:8192
    ds_read_b64_tr_b16 v[26:27], v8 offset:9216
    v_mfma_f32_32x32x16_bf16 v[80:95], v[32:35], v[44:47], v[80:95]
    ds_read_b64_tr_b16 v[28:29], v9 offset:8192
    ds_read_b64_tr_b16 v[30:31], v9 offset:9216
    ds_read_b128 v[20:23], v6 offset:4096
    v_mfma_f32_32x32x16_bf16 v[96:111], v[36:39], v[40:43], v[96:111]
    v_mfma_f32_32x32x16_bf16 v[112:127], v[36:39], v[44:47], v[112:127]
    s_waitcnt lgkmcnt(0)
    v_mfma_f32_32x32x16_bf16 v[64:79], v[16:19], v[24:27], v[64:79]
    ds_read_b128 v[32:35], v7 offset:0
    ds_read_b64_tr_b16 v[40:41], v8 offset:12288
    ds_read_b64_tr_b16 v[42:43], v8 offset:13312
    v_mfma_f32_32x32x16_bf16 v[80:95], v[16:19], v[28:31], v[80:95]
    ds_read_b64_tr_b16 v[44:45], v9 offset:12288
    ds_read_b64_tr_b16 v[46:47], v9 offset:13312
    ds_read_b128 v[36:39], v7 offset:4096
    v_mfma_f32_32x32x16_bf16 v[96:111], v[20:23], v[24:27], v[96:111]
    v_mfma_f32_32x32x16_bf16 v[112:127], v[20:23], v[28:31], v[112:127]
    s_waitcnt lgkmcnt(0)
    s_barrier
    v_mfma_f32_32x32x16_bf16 v[64:79], v[32:35], v[40:43], v[64:79]
    ds_read_b128 v[16:19], v4 offset:16384
    ds_read_b64_tr_b16 v[24:25], v8 offset:16384
    ds_read_b64_tr_b16 v[26:27], v8 offset:17408
    v_mfma_f32_32x32x16_bf16 v[80:95], v[32:35], v[44:47], v[80:95]
    ds_read_b64_tr_b16 v[28:29], v9 offset:16384
    ds_read_b64_tr_b16 v[30:31], v9 offset:17408
    ds_read_b128 v[20:23], v4 offset:20480
    v_mfma_f32_32x32x16_bf16 v[96:111], v[36:39], v[40:43], v[96:111]
    v_mfma_f32_32x32x16_bf16 v[112:127], v[36:39], v[44:47], v[112:127]
    s_waitcnt lgkmcnt(0)
    v_mfma_f32_32x32x16_bf16 v[64:79], v[16:19], v[24:27], v[64:79]
    ds_read_b128 v[32:35], v5 offset:16384
    ds_read_b64_tr_b16 v[40:41], v8 offset:20480
    ds_read_b64_tr_b16 v[42:43], v8 offset:21504
    v_mfma_f32_32x32x16_bf16 v[80:95], v[16:19], v[28:31], v[80:95]
    ds_read_b64_tr_b16 v[44:45], v9 offset:20480
    ds_read_b64_tr_b16 v[46:47], v9 offset:21504
    ds_read_b128 v[36:39], v5 offset:20480
    v_mfma_f32_32x32x16_bf16 v[96:111], v[20:23], v[24:27], v[96:111]
    v_mov_b32 v203, 0
    global_load_dwordx2 v[204:205], v203, s[68:69] sc1
    v_mfma_f32_32x32x16_bf16 v[112:127], v[20:23], v[28:31], v[112:127]
    s_waitcnt lgkmcnt(0)
    v_mfma_f32_32x32x16_bf16 v[64:79], v[32:35], v[40:43], v[64:79]
    ds_read_b128 v[16:19], v6 offset:16384
    ds_read_b64_tr_b16 v[24:25], v8 offset:24576
    ds_read_b64_tr_b16 v[26:27], v8 offset:25600
    v_mfma_f32_32x32x16_bf16 v[80:95], v[32:35], v[44:47], v[80:95]
    ds_read_b64_tr_b16 v[28:29], v9 offset:24576
    ds_read_b64_tr_b16 v[30:31], v9 offset:25600
    ds_read_b128 v[20:23], v6 offset:20480
    v_mfma_f32_32x32x16_bf16 v[96:111], v[36:39], v[40:43], v[96:111]
    v_mfma_f32_32x32x16_bf16 v[112:127], v[36:39], v[44:47], v[112:127]
    s_waitcnt lgkmcnt(0)
    v_mfma_f32_32x32x16_bf16 v[64:79], v[16:19], v[24:27], v[64:79]
    ds_read_b128 v[32:35], v7 offset:16384
    ds_read_b64_tr_b16 v[40:41], v8 offset:28672
    ds_read_b64_tr_b16 v[42:43], v8 offset:29696
    v_mfma_f32_32x32x16_bf16 v[80:95], v[16:19], v[28:31], v[80:95]
    ds_read_b64_tr_b16 v[44:45], v9 offset:28672
    ds_read_b64_tr_b16 v[46:47], v9 offset:29696
    ds_read_b128 v[36:39], v7 offset:20480
    v_mfma_f32_32x32x16_bf16 v[96:111], v[20:23], v[24:27], v[96:111]
    v_mfma_f32_32x32x16_bf16 v[112:127], v[20:23], v[28:31], v[112:127]
    s_waitcnt lgkmcnt(0)
    s_barrier
    v_mfma_f32_32x32x16_bf16 v[64:79], v[32:35], v[40:43], v[64:79]
    ds_read_b128 v[16:19], v4 offset:32768
    ds_read_b64_tr_b16 v[24:25], v8 offset:32768
    ds_read_b64_tr_b16 v[26:27], v8 offset:33792
    v_mfma_f32_32x32x16_bf16 v[80:95], v[32:35], v[44:47], v[80:95]
    ds_read_b64_tr_b16 v[28:29], v9 offset:32768
    ds_read_b64_tr_b16 v[30:31], v9 offset:33792
    ds_read_b128 v[20:23], v4 offset:36864
    v_mfma_f32_32x32x16_bf16 v[96:111], v[36:39], v[40:43], v[96:111]
    v_mfma_f32_32x32x16_bf16 v[112:127], v[36:39], v[44:47], v[112:127]
    s_waitcnt lgkmcnt(0)
    v_mfma_f32_32x32x16_bf16 v[64:79], v[16:19], v[24:27], v[64:79]
    ds_read_b128 v[32:35], v5 offset:32768
    ds_read_b64_tr_b16 v[40:41], v8 offset:36864
    ds_read_b64_tr_b16 v[42:43], v8 offset:37888
    v_mfma_f32_32x32x16_bf16 v[80:95], v[16:19], v[28:31], v[80:95]
    ds_read_b64_tr_b16 v[44:45], v9 offset:36864
    ds_read_b64_tr_b16 v[46:47], v9 offset:37888
    ds_read_b128 v[36:39], v5 offset:36864
    v_mfma_f32_32x32x16_bf16 v[96:111], v[20:23], v[24:27], v[96:111]
    v_mfma_f32_32x32x16_bf16 v[112:127], v[20:23], v[28:31], v[112:127]
    s_waitcnt lgkmcnt(0)
    v_mfma_f32_32x32x16_bf16 v[64:79], v[32:35], v[40:43], v[64:79]
    ds_read_b128 v[16:19], v6 offset:32768
    ds_read_b64_tr_b16 v[24:25], v8 offset:40960
    ds_read_b64_tr_b16 v[26:27], v8 offset:41984
    v_mfma_f32_32x32x16_bf16 v[80:95], v[32:35], v[44:47], v[80:95]
    ds_read_b64_tr_b16 v[28:29], v9 offset:40960
    ds_read_b64_tr_b16 v[30:31], v9 offset:41984
    ds_read_b128 v[20:23], v6 offset:36864
    v_mfma_f32_32x32x16_bf16 v[96:111], v[36:39], v[40:43], v[96:111]
    v_mfma_f32_32x32x16_bf16 v[112:127], v[36:39], v[44:47], v[112:127]
    s_waitcnt lgkmcnt(0)
    v_mfma_f32_32x32x16_bf16 v[64:79], v[16:19], v[24:27], v[64:79]
    ds_read_b128 v[32:35], v7 offset:32768
    ds_read_b64_tr_b16 v[40:41], v8 offset:45056
    ds_read_b64_tr_b16 v[42:43], v8 offset:46080
    v_mfma_f32_32x32x16_bf16 v[80:95], v[16:19], v[28:31], v[80:95]
    ds_read_b64_tr_b16 v[44:45], v9 offset:45056
    ds_read_b64_tr_b16 v[46:47], v9 offset:46080
    ds_read_b128 v[36:39], v7 offset:36864
    v_mfma_f32_32x32x16_bf16 v[96:111], v[20:23], v[24:27], v[96:111]
    s_mov_b32 s62, 0
F_tagv_spin:
    s_waitcnt vmcnt(0)
    v_readfirstlane_b32 s48, v204
    v_readfirstlane_b32 s49, v205
    s_cmp_lg_u32 s48, 0
    s_cbranch_scc1 F_tagv_ok
    v_mov_b32 v203, 0
    global_load_dwordx2 v[204:205], v203, s[68:69] sc1
    s_add_u32 s62, s62, 1
    s_cmp_lt_u32 s62, 262144
    s_cbranch_scc1 F_tagv_spin
F_tagv_ok:
    v_mov_b32 v188, s48
    v_mov_b32 v189, s49
    v_lshlrev_b32 v190, 3, v1
    v_mfma_f32_32x32x16_bf16 v[112:127], v[20:23], v[28:31], v[112:127]
    s_waitcnt lgkmcnt(0)
    s_barrier
    v_mfma_f32_32x32x16_bf16 v[64:79], v[32:35], v[40:43], v[64:79]
    ds_read_b128 v[16:19], v4 offset:49152
    ds_read_b64_tr_b16 v[24:25], v8 offset:49152
    ds_read_b64_tr_b16 v[26:27], v8 offset:50176
    v_mfma_f32_32x32x16_bf16 v[80:95], v[32:35], v[44:47], v[80:95]
    ds_read_b64_tr_b16 v[28:29], v9 offset:49152
    ds_read_b64_tr_b16 v[30:31], v9 offset:50176
    ds_read_b128 v[48:51], v5 offset:49152
    v_mfma_f32_32x32x16_bf16 v[96:111], v[36:39], v[40:43], v[96:111]
    ds_read_b64_tr_b16 v[56:57], v8 offset:53248
    ds_read_b64_tr_b16 v[58:59], v8 offset:54272
    v_mfma_f32_32x32x16_bf16 v[112:127], v[36:39], v[44:47], v[112:127]
    ds_read_b64_tr_b16 v[60:61], v9 offset:53248
    ds_read_b64_tr_b16 v[62:63], v9 offset:54272
    s_waitcnt lgkmcnt(5)
    v_mfma_f32_32x32x16_bf16 v[64:79], v[16:19], v[24:27], v[64:79]
    ds_read_b128 v[128:131], v6 offset:49152
    ds_read_b64_tr_b16 v[136:137], v8 offset:57344
    ds_read_b64_tr_b16 v[138:139], v8 offset:58368
    v_mfma_f32_32x32x16_bf16 v[80:95], v[16:19], v[28:31], v[80:95]
    ds_read_b64_tr_b16 v[140:141], v9 offset:57344
    ds_read_b64_tr_b16 v[142:143], v9 offset:58368
    s_waitcnt lgkmcnt(5)
    v_mfma_f32_32x32x16_bf16 v[64:79], v[48:51], v[56:59], v[64:79]
    ds_read_b128 v[32:35], v7 offset:49152
    ds_read_b64_tr_b16 v[40:41], v8 offset:61440
    ds_read_b64_tr_b16 v[42:43], v8 offset:62464
    v_mfma_f32_32x32x16_bf16 v[80:95], v[48:51], v[60:63], v[80:95]
    ds_read_b64_tr_b16 v[44:45], v9 offset:61440
    ds_read_b64_tr_b16 v[46:47], v9 offset:62464
    s_waitcnt lgkmcnt(5)
    v_mfma_f32_32x32x16_bf16 v[64:79], v[128:131], v[136:139], v[64:79]
    ds_read_b128 v[20:23], v4 offset:53248
    ds_read_b128 v[52:55], v5 offset:53248
    v_mfma_f32_32x32x16_bf16 v[80:95], v[128:131], v[140:143], v[80:95]
    ds_read_b128 v[132:135], v6 offset:53248
    ds_read_b128 v[36:39], v7 offset:53248
    s_waitcnt lgkmcnt(4)
    v_mfma_f32_32x32x16_bf16 v[64:79], v[32:35], v[40:43], v[64:79]
    v_mfma_f32_32x32x16_bf16 v[80:95], v[32:35], v[44:47], v[80:95]
    s_waitcnt lgkmcnt(0)
    v_mfma_f32_32x32x16_bf16 v[96:111], v[20:23], v[24:27], v[96:111]
    s_nop 6
    v_mfma_f32_32x32x16_bf16 v[112:127], v[20:23], v[28:31], v[112:127]
    v_pk_mul_f32 v[64:65], v[64:65], s[32:33]
    v_pk_mul_f32 v[66:67], v[66:67], s[32:33]
    v_pk_mul_f32 v[68:69], v[68:69], s[32:33]
    v_pk_mul_f32 v[70:71], v[70:71], s[32:33]
    v_cvt_pk_bf16_f32 v144, v64, v65
    v_mfma_f32_32x32x16_bf16 v[96:111], v[52:55], v[56:59], v[96:111]
    v_cvt_pk_bf16_f32 v145, v66, v67
    v_cvt_pk_bf16_f32 v146, v68, v69
    v_cvt_pk_bf16_f32 v147, v70, v71
    s_mov_b64 exec, s[44:45]
    buffer_store_dwordx4 v[144:147], v176, s[24:27], s36 offen sc1
    s_mov_b64 exec, -1
    v_pk_mul_f32 v[72:73], v[72:73], s[32:33]
    v_mfma_f32_32x32x16_bf16 v[112:127], v[52:55], v[60:63], v[112:127]
    v_pk_mul_f32 v[74:75], v[74:75], s[32:33]
    v_pk_mul_f32 v[76:77], v[76:77], s[32:33]
    v_pk_mul_f32 v[78:79], v[78:79], s[32:33]
    v_cvt_pk_bf16_f32 v148, v72, v73
    v_cvt_pk_bf16_f32 v149, v74, v75
    v_mfma_f32_32x32x16_bf16 v[96:111], v[132:135], v[136:139], v[96:111]
    v_cvt_pk_bf16_f32 v150, v76, v77
    v_cvt_pk_bf16_f32 v151, v78, v79
    s_mov_b64 exec, s[44:45]
    buffer_store_dwordx4 v[148:151], v176, s[24:27], s37 offen sc1
    s_mov_b64 exec, -1
    v_pk_mul_f32 v[80:81], v[80:81], s[32:33]
    v_pk_mul_f32 v[82:83], v[82:83], s[32:33]
    v_pk_mul_f32 v[84:85], v[84:85], s[32:33]
    v_mfma_f32_32x32x16_bf16 v[112:127], v[132:135], v[140:143], v[112:127]
    v_pk_mul_f32 v[86:87], v[86:87], s[32:33]
    v_cvt_pk_bf16_f32 v152, v80, v81
    v_cvt_pk_bf16_f32 v153, v82, v83
    v_cvt_pk_bf16_f32 v154, v84, v85
    v_cvt_pk_bf16_f32 v155, v86, v87
    v_mfma_f32_32x32x16_bf16 v[96:111], v[36:39], v[40:43], v[96:111]
    s_mov_b64 exec, s[44:45]
    buffer_store_dwordx4 v[152:155], v176, s[24:27], s38 offen sc1
    s_mov_b64 exec, -1
    v_pk_mul_f32 v[88:89], v[88:89], s[32:33]
    v_pk_mul_f32 v[90:91], v[90:91], s[32:33]
    v_pk_mul_f32 v[92:93], v[92:93], s[32:33]
    v_pk_mul_f32 v[94:95], v[94:95], s[32:33]
    v_mfma_f32_32x32x16_bf16 v[112:127], v[36:39], v[44:47], v[112:127]
    v_cvt_pk_bf16_f32 v156, v88, v89
    v_cvt_pk_bf16_f32 v157, v90, v91
    v_cvt_pk_bf16_f32 v158, v92, v93
    v_cvt_pk_bf16_f32 v159, v94, v95
    s_mov_b64 exec, s[44:45]
    buffer_store_dwordx4 v[156:159], v176, s[24:27], s39 offen sc1
    s_mov_b64 exec, -1
    s_cmp_le_u32 s15, 1
    s_nop 0
    s_cbranch_scc0 F_epi_late
    v_pk_mul_f32 v[96:97], v[96:97], s[32:33]
    v_pk_mul_f32 v[98:99], v[98:99], s[32:33]
    v_pk_mul_f32 v[100:101], v[100:101], s[32:33]
    v_pk_mul_f32 v[102:103], v[102:103], s[32:33]
    v_cvt_pk_bf16_f32 v160, v96, v97
    v_cvt_pk_bf16_f32 v161, v98, v99
    v_cvt_pk_bf16_f32 v162, v100, v101
    v_cvt_pk_bf16_f32 v163, v102, v103
    buffer_store_dwordx4 v[160:163], v176, s[24:27], s40 offen sc1
    v_pk_mul_f32 v[104:105], v[104:105], s[32:33]
    v_pk_mul_f32 v[106:107], v[106:107], s[32:33]
    v_pk_mul_f32 v[108:109], v[108:109], s[32:33]
    v_pk_mul_f32 v[110:111], v[110:111], s[32:33]
    v_cvt_pk_bf16_f32 v164, v104, v105
    v_cvt_pk_bf16_f32 v165, v106, v107
    v_cvt_pk_bf16_f32 v166, v108, v109
    v_cvt_pk_bf16_f32 v167, v110, v111
    buffer_store_dwordx4 v[164:167], v176, s[24:27], s41 offen sc1
    v_pk_mul_f32 v[112:113], v[112:113], s[32:33]
    v_pk_mul_f32 v[114:115], v[114:115], s[32:33]
    v_pk_mul_f32 v[116:117], v[116:117], s[32:33]
    v_pk_mul_f32 v[118:119], v[118:119], s[32:33]
    v_cvt_pk_bf16_f32 v168, v112, v113
    v_cvt_pk_bf16_f32 v169, v114, v115
    v_cvt_pk_bf16_f32 v170, v116, v117
    v_cvt_pk_bf16_f32 v171, v118, v119
    buffer_store_dwordx4 v[168:171], v176, s[24:27], s42 offen sc1
    v_pk_mul_f32 v[120:121], v[120:121], s[32:33]
    v_pk_mul_f32 v[122:123], v[122:123], s[32:33]
    v_pk_mul_f32 v[124:125], v[124:125], s[32:33]
    v_pk_mul_f32 v[126:127], v[126:127], s[32:33]
    v_cvt_pk_bf16_f32 v172, v120, v121
    v_cvt_pk_bf16_f32 v173, v122, v123
    v_cvt_pk_bf16_f32 v174, v124, v125
    v_cvt_pk_bf16_f32 v175, v126, v127
    buffer_store_dwordx4 v[172:175], v176, s[24:27], s43 offen sc1
    s_cmp_lg_u32 s15, 0
    s_cbranch_scc1 F_p1done
    s_mov_b64 exec, 65535
    s_waitcnt vmcnt(0)
    buffer_store_dwordx2 v[188:189], v190, s[24:27], s14 offen sc1
    s_mov_b64 exec, -1
    s_barrier
    s_branch F_p1done
F_epi_late:
    v_pk_mul_f32 v[96:97], v[96:97], s[32:33]
    v_pk_mul_f32 v[98:99], v[98:99], s[32:33]
    v_pk_mul_f32 v[100:101], v[100:101], s[32:33]
    v_pk_mul_f32 v[102:103], v[102:103], s[32:33]
    v_cvt_pk_bf16_f32 v160, v96, v97
    v_cvt_pk_bf16_f32 v161, v98, v99
    v_cvt_pk_bf16_f32 v162, v100, v101
    v_cvt_pk_bf16_f32 v163, v102, v103
    v_pk_mul_f32 v[104:105], v[104:105], s[32:33]
    v_pk_mul_f32 v[106:107], v[106:107], s[32:33]
    v_pk_mul_f32 v[108:109], v[108:109], s[32:33]
    v_pk_mul_f32 v[110:111], v[110:111], s[32:33]
    v_cvt_pk_bf16_f32 v164, v104, v105
    v_cvt_pk_bf16_f32 v165, v106, v107
    v_cvt_pk_bf16_f32 v166, v108, v109
    v_cvt_pk_bf16_f32 v167, v110, v111
    v_pk_mul_f32 v[112:113], v[112:113], s[32:33]
    v_pk_mul_f32 v[114:115], v[114:115], s[32:33]
    v_pk_mul_f32 v[116:117], v[116:117], s[32:33]
    v_pk_mul_f32 v[118:119], v[118:119], s[32:33]
    v_cvt_pk_bf16_f32 v168, v112, v113
    v_cvt_pk_bf16_f32 v169, v114, v115
    v_cvt_pk_bf16_f32 v170, v116, v117
    v_cvt_pk_bf16_f32 v171, v118, v119
    v_pk_mul_f32 v[120:121], v[120:121], s[32:33]
    v_pk_mul_f32 v[122:123], v[122:123], s[32:33]
    v_pk_mul_f32 v[124:125], v[124:125], s[32:33]
    v_pk_mul_f32 v[126:127], v[126:127], s[32:33]
    v_cvt_pk_bf16_f32 v172, v120, v121
    v_cvt_pk_bf16_f32 v173, v122, v123
    v_cvt_pk_bf16_f32 v174, v124, v125
    v_cvt_pk_bf16_f32 v175, v126, v127
    s_branch F_p1done
F_cf:
    v_bfe_u32 v13, v2, 1, 3
    v_xor_b32 v13, v13, v3
    v_lshlrev_b32 v13, 4, v13
    v_lshl_add_u32 v4, v2, 7, v13
    v_xor_b32 v5, 32, v4
    v_xor_b32 v6, 64, v4
    v_xor_b32 v7, 96, v4
    s_lshl_b32 s3, s8, 5
    v_add_u32 v12, s3, v2
    v_bfe_u32 v13, v12, 1, 3
    v_xor_b32 v13, v13, v3
    v_lshlrev_b32 v13, 4, v13
    v_lshl_add_u32 v8, v12, 7, v13
    v_add_u32 v8, 65536, v8
    v_xor_b32 v9, 32, v8
    v_xor_b32 v10, 64, v8
    v_xor_b32 v11, 96, v8
    v_bfe_u32 v13, v2, 2, 1
    v_lshlrev_b32 v13, 3, v13
    v_lshrrev_b32 v14, 3, v2
    v_lshl_add_u32 v13, v14, 1, v13
    v_bfe_u32 v14, v2, 1, 1
    v_add_u32 v13, v13, v14
    v_and_b32 v14, 1, v2
    v_cmp_eq_u32 vcc, 1, v2
    v_cvt_f32_u32 v14, v14
    v_mul_f32 v14, 0xbe800000, v14
    v_cndmask_b32 v13, v13, 16, vcc
    v_cndmask_b32 v14, v14, 0, vcc
    v_cvt_f32_u32 v13, v13
    v_mul_f32 v13, 0x3d000000, v13
    v_cvt_f32_u32 v15, v3
    v_mul_f32 v15, 4.0, v15
    v_fma_f32 v14, v15, v13, v14
    s_mov_b32 s3, 0x0
    v_fma_f32 v136, s3, v13, v14
    v_cos_f32 v136, v136
    s_mov_b32 s3, 0x3f800000
    v_fma_f32 v137, s3, v13, v14
    v_cos_f32 v137, v137
    s_nop 0
    v_cvt_pk_bf16_f32 v128, v136, v137
    s_mov_b32 s3, 0x40000000
    v_fma_f32 v136, s3, v13, v14
    v_cos_f32 v136, v136
    s_mov_b32 s3, 0x40400000
    v_fma_f32 v137, s3, v13, v14
    v_cos_f32 v137, v137
    s_nop 0
    v_cvt_pk_bf16_f32 v129, v136, v137
    s_mov_b32 s3, 0x41000000
    v_fma_f32 v136, s3, v13, v14
    v_cos_f32 v136, v136
    s_mov_b32 s3, 0x41100000
    v_fma_f32 v137, s3, v13, v14
    v_cos_f32 v137, v137
    s_nop 0
    v_cvt_pk_bf16_f32 v130, v136, v137
    s_mov_b32 s3, 0x41200000
    v_fma_f32 v136, s3, v13, v14
    v_cos_f32 v136, v136
    s_mov_b32 s3, 0x41300000
    v_fma_f32 v137, s3, v13, v14
    v_cos_f32 v137, v137
    s_nop 0
    v_cvt_pk_bf16_f32 v131, v136, v137
    s_mov_b32 s3, 0x41800000
    v_fma_f32 v136, s3, v13, v14
    v_cos_f32 v136, v136
    s_mov_b32 s3, 0x41880000
    v_fma_f32 v137, s3, v13, v14
    v_cos_f32 v137, v137
    s_nop 0
    v_cvt_pk_bf16_f32 v132, v136, v137
    s_mov_b32 s3, 0x41900000
    v_fma_f32 v136, s3, v13, v14
    v_cos_f32 v136, v136
    s_mov_b32 s3, 0x41980000
    v_fma_f32 v137, s3, v13, v14
    v_cos_f32 v137, v137
    s_nop 0
    v_cvt_pk_bf16_f32 v133, v136, v137
    s_mov_b32 s3, 0x41c00000
    v_fma_f32 v136, s3, v13, v14
    v_cos_f32 v136, v136
    s_mov_b32 s3, 0x41c80000
    v_fma_f32 v137, s3, v13, v14
    v_cos_f32 v137, v137
    s_nop 0
    v_cvt_pk_bf16_f32 v134, v136, v137
    s_mov_b32 s3, 0x41d00000
    v_fma_f32 v136, s3, v13, v14
    v_cos_f32 v136, v136
    s_mov_b32 s3, 0x41d80000
    v_fma_f32 v137, s3, v13, v14
    v_cos_f32 v137, v137
    s_nop 0
    v_cvt_pk_bf16_f32 v135, v136, v137
    v_lshlrev_b32 v14, 4, v12
    s_mov_b32 s3, 557056
    v_mad_u32_u24 v14, v3, s3, v14
    s_lshr_b32 s28, s11, 1
    s_mul_i32 s28, s28, 1114112
    v_add_u32 v14, s28, v14
    s_cmp_eq_u32 s11, 2
    s_cselect_b32 s28, 0, -1
    v_cmp_eq_u32 vcc, s28, v12
    v_subrev_u32 v15, 1112064, v14
    s_and_b32 s30, s11, 1
    v_cndmask_b32 v176, v14, v15, vcc
    s_mul_i32 s30, s30, 2176
    s_mul_i32 s31, s10, 4352
    s_add_u32 s30, s30, s31
    s_mov_b32 s15, 3
    s_add_u32 s36, s30, 8388608
    s_add_u32 s37, s30, 8458240
    s_add_u32 s38, s30, 8527872
    s_add_u32 s39, s30, 8597504
    s_add_u32 s40, s30, 8667136
    s_add_u32 s41, s30, 8736768
    s_add_u32 s42, s30, 8806400
    s_add_u32 s43, s30, 8876032
    s_cmp_lg_u32 s8, 0
    s_cbranch_scc1 F_gof
    s_cmp_eq_u32 s15, 0
    s_cbranch_scc1 F_gof
    v_mov_b32 v203, 0
    global_load_dwordx2 v[204:205], v203, s[68:69] sc1
    s_mov_b32 s62, 0
F_tagwf_spin:
    s_waitcnt vmcnt(0)
    v_readfirstlane_b32 s48, v204
    v_readfirstlane_b32 s49, v205
    s_cmp_lg_u32 s48, 0
    s_cbranch_scc1 F_tagwf_ok
    v_mov_b32 v203, 0
    global_load_dwordx2 v[204:205], v203, s[68:69] sc1
    s_add_u32 s62, s62, 1
    s_cmp_lt_u32 s62, 262144
    s_cbranch_scc1 F_tagwf_spin
F_tagwf_ok:
F_gof:
    s_barrier
    ds_read_b128 v[32:35], v8 offset:0
    ds_read_b128 v[16:19], v4 offset:0
    ds_read_b128 v[20:23], v4 offset:4096
    ds_read_b128 v[24:27], v4 offset:8192
    ds_read_b128 v[28:31], v4 offset:12288
    s_waitcnt lgkmcnt(0)
    v_mfma_f32_32x32x16_bf16 v[64:79], v[16:19], v[32:35], 0
    ds_read_b128 v[52:55], v9 offset:0
    ds_read_b128 v[36:39], v5 offset:0
    v_mfma_f32_32x32x16_bf16 v[80:95], v[20:23], v[32:35], 0
    ds_read_b128 v[40:43], v5 offset:4096
    ds_read_b128 v[44:47], v5 offset:8192
    v_mfma_f32_32x32x16_bf16 v[96:111], v[24:27], v[32:35], 0
    ds_read_b128 v[48:51], v5 offset:12288
    v_mfma_f32_32x32x16_bf16 v[112:127], v[28:31], v[32:35], 0
    s_waitcnt lgkmcnt(0)
    v_mfma_f32_32x32x16_bf16 v[64:79], v[36:39], v[52:55], v[64:79]
    ds_read_b128 v[32:35], v10 offset:0
    ds_read_b128 v[16:19], v6 offset:0
    v_mfma_f32_32x32x16_bf16 v[80:95], v[40:43], v[52:55], v[80:95]
    ds_read_b128 v[20:23], v6 offset:4096
    ds_read_b128 v[24:27], v6 offset:8192
    v_mfma_f32_32x32x16_bf16 v[96:111], v[44:47], v[52:55], v[96:111]
    ds_read_b128 v[28:31], v6 offset:12288
    v_mfma_f32_32x32x16_bf16 v[112:127], v[48:51], v[52:55], v[112:127]
    s_waitcnt lgkmcnt(0)
    v_mfma_f32_32x32x16_bf16 v[64:79], v[16:19], v[32:35], v[64:79]
    ds_read_b128 v[52:55], v11 offset:0
    ds_read_b128 v[36:39], v7 offset:0
    v_mfma_f32_32x32x16_bf16 v[80:95], v[20:23], v[32:35], v[80:95]
    ds_read_b128 v[40:43], v7 offset:4096
    ds_read_b128 v[44:47], v7 offset:8192
    v_mfma_f32_32x32x16_bf16 v[96:111], v[24:27], v[32:35], v[96:111]
    ds_read_b128 v[48:51], v7 offset:12288
    v_mfma_f32_32x32x16_bf16 v[112:127], v[28:31], v[32:35], v[112:127]
    s_waitcnt lgkmcnt(0)
    s_barrier
    v_mfma_f32_32x32x16_bf16 v[64:79], v[36:39], v[52:55], v[64:79]
    ds_read_b128 v[32:35], v8 offset:16384
    ds_read_b128 v[16:19], v4 offset:16384
    v_mfma_f32_32x32x16_bf16 v[80:95], v[40:43], v[52:55], v[80:95]
    ds_read_b128 v[20:23], v4 offset:20480
    ds_read_b128 v[24:27], v4 offset:24576
    v_mfma_f32_32x32x16_bf16 v[96:111], v[44:47], v[52:55], v[96:111]
    ds_read_b128 v[28:31], v4 offset:28672
    v_mfma_f32_32x32x16_bf16 v[112:127], v[48:51], v[52:55], v[112:127]
    s_waitcnt lgkmcnt(0)
    v_mfma_f32_32x32x16_bf16 v[64:79], v[16:19], v[32:35], v[64:79]
    ds_read_b128 v[52:55], v9 offset:16384
    ds_read_b128 v[36:39], v5 offset:16384
    v_mfma_f32_32x32x16_bf16 v[80:95], v[20:23], v[32:35], v[80:95]
    ds_read_b128 v[40:43], v5 offset:20480
    ds_read_b128 v[44:47], v5 offset:24576
    v_mfma_f32_32x32x16_bf16 v[96:111], v[24:27], v[32:35], v[96:111]
    ds_read_b128 v[48:51], v5 offset:28672
    v_mfma_f32_32x32x16_bf16 v[112:127], v[28:31], v[32:35], v[112:127]
    s_waitcnt lgkmcnt(0)
    v_mfma_f32_32x32x16_bf16 v[64:79], v[36:39], v[52:55], v[64:79]
    ds_read_b128 v[32:35], v10 offset:16384
    ds_read_b128 v[16:19], v6 offset:16384
    v_mfma_f32_32x32x16_bf16 v[80:95], v[40:43], v[52:55], v[80:95]
    ds_read_b128 v[20:23], v6 offset:20480
    ds_read_b128 v[24:27], v6 offset:24576
    v_mfma_f32_32x32x16_bf16 v[96:111], v[44:47], v[52:55], v[96:111]
    ds_read_b128 v[28:31], v6 offset:28672
    v_mfma_f32_32x32x16_bf16 v[112:127], v[48:51], v[52:55], v[112:127]
    s_waitcnt lgkmcnt(0)
    v_mfma_f32_32x32x16_bf16 v[64:79], v[16:19], v[32:35], v[64:79]
    ds_read_b128 v[52:55], v11 offset:16384
    ds_read_b128 v[36:39], v7 offset:16384
    v_mfma_f32_32x32x16_bf16 v[80:95], v[20:23], v[32:35], v[80:95]
    ds_read_b128 v[40:43], v7 offset:20480
    ds_read_b128 v[44:47], v7 offset:24576
    v_mfma_f32_32x32x16_bf16 v[96:111], v[24:27], v[32:35], v[96:111]
    ds_read_b128 v[48:51], v7 offset:28672
    v_mfma_f32_32x32x16_bf16 v[112:127], v[28:31], v[32:35], v[112:127]
    s_waitcnt lgkmcnt(0)
    s_barrier
    v_mfma_f32_32x32x16_bf16 v[64:79], v[36:39], v[52:55], v[64:79]
    ds_read_b128 v[32:35], v8 offset:32768
    ds_read_b128 v[16:19], v4 offset:32768
    v_mfma_f32_32x32x16_bf16 v[80:95], v[40:43], v[52:55], v[80:95]
    ds_read_b128 v[20:23], v4 offset:36864
    ds_read_b128 v[24:27], v4 offset:40960
    v_mfma_f32_32x32x16_bf16 v[96:111], v[44:47], v[52:55], v[96:111]
    ds_read_b128 v[28:31], v4 offset:45056
    v_mfma_f32_32x32x16_bf16 v[112:127], v[48:51], v[52:55], v[112:127]
    s_waitcnt lgkmcnt(0)
    v_mfma_f32_32x32x16_bf16 v[64:79], v[16:19], v[32:35], v[64:79]
    ds_read_b128 v[52:55], v9 offset:32768
    ds_read_b128 v[36:39], v5 offset:32768
    v_mfma_f32_32x32x16_bf16 v[80:95], v[20:23], v[32:35], v[80:95]
    ds_read_b128 v[40:43], v5 offset:36864
    ds_read_b128 v[44:47], v5 offset:40960
    v_mfma_f32_32x32x16_bf16 v[96:111], v[24:27], v[32:35], v[96:111]
    ds_read_b128 v[48:51], v5 offset:45056
    v_mfma_f32_32x32x16_bf16 v[112:127], v[28:31], v[32:35], v[112:127]
    s_waitcnt lgkmcnt(0)
    v_mfma_f32_32x32x16_bf16 v[64:79], v[36:39], v[52:55], v[64:79]
    ds_read_b128 v[32:35], v10 offset:32768
    ds_read_b128 v[16:19], v6 offset:32768
    v_mfma_f32_32x32x16_bf16 v[80:95], v[40:43], v[52:55], v[80:95]
    ds_read_b128 v[20:23], v6 offset:36864
    ds_read_b128 v[24:27], v6 offset:40960
    v_mfma_f32_32x32x16_bf16 v[96:111], v[44:47], v[52:55], v[96:111]
    ds_read_b128 v[28:31], v6 offset:45056
    v_mfma_f32_32x32x16_bf16 v[112:127], v[48:51], v[52:55], v[112:127]
    s_waitcnt lgkmcnt(0)
    v_mfma_f32_32x32x16_bf16 v[64:79], v[16:19], v[32:35], v[64:79]
    ds_read_b128 v[52:55], v11 offset:32768
    ds_read_b128 v[36:39], v7 offset:32768
    v_mfma_f32_32x32x16_bf16 v[80:95], v[20:23], v[32:35], v[80:95]
    ds_read_b128 v[40:43], v7 offset:36864
    ds_read_b128 v[44:47], v7 offset:40960
    v_mfma_f32_32x32x16_bf16 v[96:111], v[24:27], v[32:35], v[96:111]
    ds_read_b128 v[48:51], v7 offset:45056
    v_mfma_f32_32x32x16_bf16 v[112:127], v[28:31], v[32:35], v[112:127]
    s_waitcnt lgkmcnt(0)
    s_barrier
    v_mfma_f32_32x32x16_bf16 v[64:79], v[36:39], v[52:55], v[64:79]
    ds_read_b128 v[32:35], v8 offset:49152
    ds_read_b128 v[16:19], v4 offset:49152
    v_mfma_f32_32x32x16_bf16 v[80:95], v[40:43], v[52:55], v[80:95]
    ds_read_b128 v[20:23], v4 offset:53248
    ds_read_b128 v[24:27], v4 offset:57344
    v_mfma_f32_32x32x16_bf16 v[96:111], v[44:47], v[52:55], v[96:111]
    ds_read_b128 v[28:31], v4 offset:61440
    v_mfma_f32_32x32x16_bf16 v[112:127], v[48:51], v[52:55], v[112:127]
    s_waitcnt lgkmcnt(0)
    v_mfma_f32_32x32x16_bf16 v[64:79], v[16:19], v[32:35], v[64:79]
    ds_read_b128 v[52:55], v9 offset:49152
    ds_read_b128 v[36:39], v5 offset:49152
    v_mfma_f32_32x32x16_bf16 v[80:95], v[20:23], v[32:35], v[80:95]
    ds_read_b128 v[40:43], v5 offset:53248
    ds_read_b128 v[44:47], v5 offset:57344
    v_mfma_f32_32x32x16_bf16 v[96:111], v[24:27], v[32:35], v[96:111]
    ds_read_b128 v[48:51], v5 offset:61440
    v_mfma_f32_32x32x16_bf16 v[112:127], v[28:31], v[32:35], v[112:127]
    s_waitcnt lgkmcnt(0)
    v_mfma_f32_32x32x16_bf16 v[64:79], v[36:39], v[52:55], v[64:79]
    ds_read_b128 v[32:35], v10 offset:49152
    ds_read_b128 v[16:19], v6 offset:49152
    v_mfma_f32_32x32x16_bf16 v[80:95], v[40:43], v[52:55], v[80:95]
    ds_read_b128 v[20:23], v6 offset:53248
    ds_read_b128 v[24:27], v6 offset:57344
    v_mfma_f32_32x32x16_bf16 v[96:111], v[44:47], v[52:55], v[96:111]
    ds_read_b128 v[28:31], v6 offset:61440
    v_mfma_f32_32x32x16_bf16 v[112:127], v[48:51], v[52:55], v[112:127]
    s_waitcnt lgkmcnt(0)
    v_mfma_f32_32x32x16_bf16 v[64:79], v[16:19], v[32:35], v[64:79]
    ds_read_b128 v[52:55], v11 offset:49152
    ds_read_b128 v[36:39], v7 offset:49152
    v_mfma_f32_32x32x16_bf16 v[80:95], v[20:23], v[32:35], v[80:95]
    ds_read_b128 v[40:43], v7 offset:53248
    ds_read_b128 v[44:47], v7 offset:57344
    v_mfma_f32_32x32x16_bf16 v[96:111], v[24:27], v[32:35], v[96:111]
    ds_read_b128 v[48:51], v7 offset:61440
    v_mfma_f32_32x32x16_bf16 v[112:127], v[28:31], v[32:35], v[112:127]
    s_waitcnt lgkmcnt(0)
    s_barrier
    v_mfma_f32_32x32x16_bf16 v[64:79], v[36:39], v[52:55], v[64:79]
    ds_read_b128 v[32:35], v8 offset:0
    ds_read_b128 v[16:19], v4 offset:0
    v_mfma_f32_32x32x16_bf16 v[80:95], v[40:43], v[52:55], v[80:95]
    ds_read_b128 v[20:23], v4 offset:4096
    ds_read_b128 v[24:27], v4 offset:8192
    v_mfma_f32_32x32x16_bf16 v[96:111], v[44:47], v[52:55], v[96:111]
    ds_read_b128 v[28:31], v4 offset:12288
    v_mfma_f32_32x32x16_bf16 v[112:127], v[48:51], v[52:55], v[112:127]
    s_waitcnt lgkmcnt(0)
    v_mfma_f32_32x32x16_bf16 v[64:79], v[16:19], v[32:35], v[64:79]
    ds_read_b128 v[52:55], v9 offset:0
    ds_read_b128 v[36:39], v5 offset:0
    v_mfma_f32_32x32x16_bf16 v[80:95], v[20:23], v[32:35], v[80:95]
    ds_read_b128 v[40:43], v5 offset:4096
    ds_read_b128 v[44:47], v5 offset:8192
    v_mfma_f32_32x32x16_bf16 v[96:111], v[24:27], v[32:35], v[96:111]
    ds_read_b128 v[48:51], v5 offset:12288
    v_mfma_f32_32x32x16_bf16 v[112:127], v[28:31], v[32:35], v[112:127]
    s_waitcnt lgkmcnt(0)
    v_mfma_f32_32x32x16_bf16 v[64:79], v[36:39], v[52:55], v[64:79]
    ds_read_b128 v[32:35], v10 offset:0
    ds_read_b128 v[16:19], v6 offset:0
    v_mfma_f32_32x32x16_bf16 v[80:95], v[40:43], v[52:55], v[80:95]
    ds_read_b128 v[20:23], v6 offset:4096
    ds_read_b128 v[24:27], v6 offset:8192
    v_mfma_f32_32x32x16_bf16 v[96:111], v[44:47], v[52:55], v[96:111]
    ds_read_b128 v[28:31], v6 offset:12288
    v_mfma_f32_32x32x16_bf16 v[112:127], v[48:51], v[52:55], v[112:127]
    s_waitcnt lgkmcnt(0)
    v_mfma_f32_32x32x16_bf16 v[64:79], v[16:19], v[32:35], v[64:79]
    ds_read_b128 v[52:55], v11 offset:0
    ds_read_b128 v[36:39], v7 offset:0
    v_mfma_f32_32x32x16_bf16 v[80:95], v[20:23], v[32:35], v[80:95]
    ds_read_b128 v[40:43], v7 offset:4096
    ds_read_b128 v[44:47], v7 offset:8192
    v_mfma_f32_32x32x16_bf16 v[96:111], v[24:27], v[32:35], v[96:111]
    ds_read_b128 v[48:51], v7 offset:12288
    v_mfma_f32_32x32x16_bf16 v[112:127], v[28:31], v[32:35], v[112:127]
    s_waitcnt lgkmcnt(0)
    s_barrier
    v_mfma_f32_32x32x16_bf16 v[64:79], v[36:39], v[52:55], v[64:79]
    ds_read_b128 v[32:35], v8 offset:16384
    ds_read_b128 v[16:19], v4 offset:16384
    v_mfma_f32_32x32x16_bf16 v[80:95], v[40:43], v[52:55], v[80:95]
    ds_read_b128 v[20:23], v4 offset:20480
    ds_read_b128 v[24:27], v4 offset:24576
    v_mfma_f32_32x32x16_bf16 v[96:111], v[44:47], v[52:55], v[96:111]
    ds_read_b128 v[28:31], v4 offset:28672
    v_mfma_f32_32x32x16_bf16 v[112:127], v[48:51], v[52:55], v[112:127]
    s_waitcnt lgkmcnt(0)
    v_mfma_f32_32x32x16_bf16 v[64:79], v[16:19], v[32:35], v[64:79]
    ds_read_b128 v[52:55], v9 offset:16384
    ds_read_b128 v[36:39], v5 offset:16384
    v_mfma_f32_32x32x16_bf16 v[80:95], v[20:23], v[32:35], v[80:95]
    ds_read_b128 v[40:43], v5 offset:20480
    ds_read_b128 v[44:47], v5 offset:24576
    v_mfma_f32_32x32x16_bf16 v[96:111], v[24:27], v[32:35], v[96:111]
    ds_read_b128 v[48:51], v5 offset:28672
    v_mov_b32 v203, 0
    global_load_dwordx2 v[204:205], v203, s[68:69] sc1
    v_mfma_f32_32x32x16_bf16 v[112:127], v[28:31], v[32:35], v[112:127]
    s_waitcnt lgkmcnt(0)
    v_mfma_f32_32x32x16_bf16 v[64:79], v[36:39], v[52:55], v[64:79]
    ds_read_b128 v[32:35], v10 offset:16384
    ds_read_b128 v[16:19], v6 offset:16384
    v_mfma_f32_32x32x16_bf16 v[80:95], v[40:43], v[52:55], v[80:95]
    ds_read_b128 v[20:23], v6 offset:20480
    ds_read_b128 v[24:27], v6 offset:24576
    v_mfma_f32_32x32x16_bf16 v[96:111], v[44:47], v[52:55], v[96:111]
    ds_read_b128 v[28:31], v6 offset:28672
    v_mfma_f32_32x32x16_bf16 v[112:127], v[48:51], v[52:55], v[112:127]
    s_waitcnt lgkmcnt(0)
    v_mfma_f32_32x32x16_bf16 v[64:79], v[16:19], v[32:35], v[64:79]
    ds_read_b128 v[52:55], v11 offset:16384
    ds_read_b128 v[36:39], v7 offset:16384
    v_mfma_f32_32x32x16_bf16 v[80:95], v[20:23], v[32:35], v[80:95]
    ds_read_b128 v[40:43], v7 offset:20480
    ds_read_b128 v[44:47], v7 offset:24576
    v_mfma_f32_32x32x16_bf16 v[96:111], v[24:27], v[32:35], v[96:111]
    ds_read_b128 v[48:51], v7 offset:28672
    v_mfma_f32_32x32x16_bf16 v[112:127], v[28:31], v[32:35], v[112:127]
    s_waitcnt lgkmcnt(0)
    s_barrier
    v_mfma_f32_32x32x16_bf16 v[64:79], v[36:39], v[52:55], v[64:79]
    ds_read_b128 v[32:35], v8 offset:32768
    ds_read_b128 v[16:19], v4 offset:32768
    v_mfma_f32_32x32x16_bf16 v[80:95], v[40:43], v[52:55], v[80:95]
    ds_read_b128 v[20:23], v4 offset:36864
    ds_read_b128 v[24:27], v4 offset:40960
    v_mfma_f32_32x32x16_bf16 v[96:111], v[44:47], v[52:55], v[96:111]
    ds_read_b128 v[28:31], v4 offset:45056
    v_mfma_f32_32x32x16_bf16 v[112:127], v[48:51], v[52:55], v[112:127]
    s_waitcnt lgkmcnt(0)
    v_mfma_f32_32x32x16_bf16 v[64:79], v[16:19], v[32:35], v[64:79]
    ds_read_b128 v[52:55], v9 offset:32768
    ds_read_b128 v[36:39], v5 offset:32768
    v_mfma_f32_32x32x16_bf16 v[80:95], v[20:23], v[32:35], v[80:95]
    ds_read_b128 v[40:43], v5 offset:36864
    ds_read_b128 v[44:47], v5 offset:40960
    v_mfma_f32_32x32x16_bf16 v[96:111], v[24:27], v[32:35], v[96:111]
    ds_read_b128 v[48:51], v5 offset:45056
    v_mfma_f32_32x32x16_bf16 v[112:127], v[28:31], v[32:35], v[112:127]
    s_waitcnt lgkmcnt(0)
    v_mfma_f32_32x32x16_bf16 v[64:79], v[36:39], v[52:55], v[64:79]
    ds_read_b128 v[32:35], v10 offset:32768
    ds_read_b128 v[16:19], v6 offset:32768
    v_mfma_f32_32x32x16_bf16 v[80:95], v[40:43], v[52:55], v[80:95]
    ds_read_b128 v[20:23], v6 offset:36864
    ds_read_b128 v[24:27], v6 offset:40960
    v_mfma_f32_32x32x16_bf16 v[96:111], v[44:47], v[52:55], v[96:111]
    ds_read_b128 v[28:31], v6 offset:45056
    v_mfma_f32_32x32x16_bf16 v[112:127], v[48:51], v[52:55], v[112:127]
    s_waitcnt lgkmcnt(0)
    v_mfma_f32_32x32x16_bf16 v[64:79], v[16:19], v[32:35], v[64:79]
    ds_read_b128 v[52:55], v11 offset:32768
    ds_read_b128 v[36:39], v7 offset:32768
    v_mfma_f32_32x32x16_bf16 v[80:95], v[20:23], v[32:35], v[80:95]
    ds_read_b128 v[40:43], v7 offset:36864
    ds_read_b128 v[44:47], v7 offset:40960
    v_mfma_f32_32x32x16_bf16 v[96:111], v[24:27], v[32:35], v[96:111]
    ds_read_b128 v[48:51], v7 offset:45056
    s_mov_b32 s62, 0
F_tagf_spin:
    s_waitcnt vmcnt(0)
    v_readfirstlane_b32 s48, v204
    v_readfirstlane_b32 s49, v205
    s_cmp_lg_u32 s48, 0
    s_cbranch_scc1 F_tagf_ok
    v_mov_b32 v203, 0
    global_load_dwordx2 v[204:205], v203, s[68:69] sc1
    s_add_u32 s62, s62, 1
    s_cmp_lt_u32 s62, 262144
    s_cbranch_scc1 F_tagf_spin
F_tagf_ok:
    v_mov_b32 v188, s48
    v_mov_b32 v189, s49
    v_lshlrev_b32 v190, 3, v1
    v_mfma_f32_32x32x16_bf16 v[112:127], v[28:31], v[32:35], v[112:127]
    s_waitcnt lgkmcnt(0)
    s_barrier
    v_mfma_f32_32x32x16_bf16 v[64:79], v[36:39], v[52:55], v[64:79]
    ds_read_b128 v[32:35], v8 offset:49152
    ds_read_b128 v[16:19], v4 offset:49152
    v_mfma_f32_32x32x16_bf16 v[80:95], v[40:43], v[52:55], v[80:95]
    ds_read_b128 v[20:23], v4 offset:53248
    ds_read_b128 v[24:27], v4 offset:57344
    v_mfma_f32_32x32x16_bf16 v[96:111], v[44:47], v[52:55], v[96:111]
    ds_read_b128 v[28:31], v4 offset:61440
    v_mfma_f32_32x32x16_bf16 v[112:127], v[48:51], v[52:55], v[112:127]
    s_waitcnt lgkmcnt(0)
    v_mfma_f32_32x32x16_bf16 v[64:79], v[16:19], v[32:35], v[64:79]
    ds_read_b128 v[52:55], v9 offset:49152
    ds_read_b128 v[36:39], v5 offset:49152
    v_mfma_f32_32x32x16_bf16 v[80:95], v[20:23], v[32:35], v[80:95]
    ds_read_b128 v[40:43], v5 offset:53248
    ds_read_b128 v[44:47], v5 offset:57344
    v_mfma_f32_32x32x16_bf16 v[96:111], v[24:27], v[32:35], v[96:111]
    ds_read_b128 v[48:51], v5 offset:61440
    v_mfma_f32_32x32x16_bf16 v[112:127], v[28:31], v[32:35], v[112:127]
    s_waitcnt lgkmcnt(0)
    v_mfma_f32_32x32x16_bf16 v[64:79], v[36:39], v[52:55], v[64:79]
    ds_read_b128 v[32:35], v10 offset:49152
    ds_read_b128 v[16:19], v6 offset:49152
    v_mfma_f32_32x32x16_bf16 v[80:95], v[40:43], v[52:55], v[80:95]
    ds_read_b128 v[20:23], v6 offset:53248
    ds_read_b128 v[24:27], v6 offset:57344
    v_mfma_f32_32x32x16_bf16 v[96:111], v[44:47], v[52:55], v[96:111]
    ds_read_b128 v[28:31], v6 offset:61440
    v_mfma_f32_32x32x16_bf16 v[112:127], v[48:51], v[52:55], v[112:127]
    s_waitcnt lgkmcnt(0)
    v_mfma_f32_32x32x16_bf16 v[64:79], v[16:19], v[32:35], v[64:79]
    ds_read_b128 v[52:55], v11 offset:49152
    ds_read_b128 v[36:39], v7 offset:49152
    v_mfma_f32_32x32x16_bf16 v[80:95], v[20:23], v[32:35], v[80:95]
    ds_read_b128 v[40:43], v7 offset:53248
    ds_read_b128 v[44:47], v7 offset:57344
    v_mfma_f32_32x32x16_bf16 v[96:111], v[24:27], v[32:35], v[96:111]
    ds_read_b128 v[48:51], v7 offset:61440
    v_mfma_f32_32x32x16_bf16 v[112:127], v[28:31], v[32:35], v[112:127]
    s_waitcnt lgkmcnt(0)
    v_mfma_f32_32x32x16_bf16 v[64:79], v[36:39], v[52:55], v[64:79]
    v_mfma_f32_32x32x16_bf16 v[80:95], v[40:43], v[52:55], v[80:95]
    v_mfma_f32_32x32x16_bf16 v[96:111], v[44:47], v[52:55], v[96:111]
    v_mfma_f32_32x32x16_bf16 v[112:127], v[48:51], v[52:55], v[112:127]
    s_nop 9
    v_cvt_pk_bf16_f32 v16, v64, v65
    v_cvt_pk_bf16_f32 v17, v66, v67
    v_cvt_pk_bf16_f32 v18, v68, v69
    v_cvt_pk_bf16_f32 v19, v70, v71
    v_cvt_pk_bf16_f32 v20, v72, v73
    v_cvt_pk_bf16_f32 v21, v74, v75
    v_cvt_pk_bf16_f32 v22, v76, v77
    v_cvt_pk_bf16_f32 v23, v78, v79
    v_cvt_pk_bf16_f32 v24, v80, v81
    v_cvt_pk_bf16_f32 v25, v82, v83
    v_cvt_pk_bf16_f32 v26, v84, v85
    v_cvt_pk_bf16_f32 v27, v86, v87
    v_cvt_pk_bf16_f32 v28, v88, v89
    v_cvt_pk_bf16_f32 v29, v90, v91
    v_cvt_pk_bf16_f32 v30, v92, v93
    v_cvt_pk_bf16_f32 v31, v94, v95
    v_cvt_pk_bf16_f32 v32, v96, v97
    v_cvt_pk_bf16_f32 v33, v98, v99
    v_cvt_pk_bf16_f32 v34, v100, v101
    v_cvt_pk_bf16_f32 v35, v102, v103
    v_cvt_pk_bf16_f32 v36, v104, v105
    v_cvt_pk_bf16_f32 v37, v106, v107
    v_cvt_pk_bf16_f32 v38, v108, v109
    v_cvt_pk_bf16_f32 v39, v110, v111
    v_cvt_pk_bf16_f32 v40, v112, v113
    v_cvt_pk_bf16_f32 v41, v114, v115
    v_cvt_pk_bf16_f32 v42, v116, v117
    v_cvt_pk_bf16_f32 v43, v118, v119
    v_cvt_pk_bf16_f32 v44, v120, v121
    v_cvt_pk_bf16_f32 v45, v122, v123
    v_cvt_pk_bf16_f32 v46, v124, v125
    v_cvt_pk_bf16_f32 v47, v126, v127
    s_nop 1
    v_mfma_f32_32x32x16_bf16 v[64:79], v[128:131], v[16:19], 0
    v_mfma_f32_32x32x16_bf16 v[80:95], v[128:131], v[24:27], 0
    v_mfma_f32_32x32x16_bf16 v[96:111], v[128:131], v[32:35], 0
    v_mfma_f32_32x32x16_bf16 v[112:127], v[128:131], v[40:43], 0
    v_mfma_f32_32x32x16_bf16 v[64:79], v[132:135], v[20:23], v[64:79]
    v_mfma_f32_32x32x16_bf16 v[80:95], v[132:135], v[28:31], v[80:95]
    v_mfma_f32_32x32x16_bf16 v[96:111], v[132:135], v[36:39], v[96:111]
    v_mfma_f32_32x32x16_bf16 v[112:127], v[132:135], v[44:47], v[112:127]
    s_nop 11
    v_cvt_pk_bf16_f32 v144, v64, v65
    v_cvt_pk_bf16_f32 v145, v80, v81
    v_cvt_pk_bf16_f32 v146, v96, v97
    v_cvt_pk_bf16_f32 v147, v112, v113
    v_cvt_pk_bf16_f32 v148, v66, v67
    v_cvt_pk_bf16_f32 v149, v82, v83
    v_cvt_pk_bf16_f32 v150, v98, v99
    v_cvt_pk_bf16_f32 v151, v114, v115
    v_cvt_pk_bf16_f32 v152, v68, v69
    v_cvt_pk_bf16_f32 v153, v84, v85
    v_cvt_pk_bf16_f32 v154, v100, v101
    v_cvt_pk_bf16_f32 v155, v116, v117
    v_cvt_pk_bf16_f32 v156, v70, v71
    v_cvt_pk_bf16_f32 v157, v86, v87
    v_cvt_pk_bf16_f32 v158, v102, v103
    v_cvt_pk_bf16_f32 v159, v118, v119
    v_cvt_pk_bf16_f32 v160, v72, v73
    v_cvt_pk_bf16_f32 v161, v88, v89
    v_cvt_pk_bf16_f32 v162, v104, v105
    v_cvt_pk_bf16_f32 v163, v120, v121
    v_cvt_pk_bf16_f32 v164, v74, v75
    v_cvt_pk_bf16_f32 v165, v90, v91
    v_cvt_pk_bf16_f32 v166, v106, v107
    v_cvt_pk_bf16_f32 v167, v122, v123
    v_cvt_pk_bf16_f32 v168, v76, v77
    v_cvt_pk_bf16_f32 v169, v92, v93
    v_cvt_pk_bf16_f32 v170, v108, v109
    v_cvt_pk_bf16_f32 v171, v124, v125
    v_cvt_pk_bf16_f32 v172, v78, v79
    v_cvt_pk_bf16_f32 v173, v94, v95
    v_cvt_pk_bf16_f32 v174, v110, v111
    v_cvt_pk_bf16_f32 v175, v126, v127
F_p1done:
    s_lshl_b32 s58, s2, 7
    s_add_u32 s58, s58, 13631488
    v_add_u32 v187, s58, v190
    v_mov_b32 v184, 0
    v_mov_b32 v185, 0
    v_mov_b32 v186, 0
    s_cmp_eq_u32 s8, 0
    s_cselect_b32 s70, 0xffff, 0
    s_mov_b32 s71, 0
    s_and_b32 s63, s50, 3
    s_lshl_b32 s63, s63, 2
    s_add_u32 s63, s63, s8
    s_lshl_b32 s63, s63, 15
    s_add_u32 s63, s63, 12582912
    s_lshl_b32 s58, s51, 3
    s_lshr_b32 s59, s50, 2
    s_add_u32 s58, s58, s59
    s_and_b32 s59, s51, 7
    s_xor_b32 s58, s58, s59
    s_lshl_b32 s58, s58, 2
    s_add_u32 s58, s58, s8
    s_lshl_b32 s58, s58, 10
    s_add_u32 s58, s58, 13893632
    v_and_b32 v218, 7, v1
    v_lshl_add_u32 v218, v218, 7, s58
    s_load_dwordx2 s[20:21], s[0:1], 64
    s_mov_b32 s22, 0x400000
    s_mov_b32 s23, 0x20000
    v_lshlrev_b32 v7, 4, v1
    v_lshlrev_b32 v28, 4, v0
    v_add_u32 v28, 141312, v28
    v_mov_b32 v3, 0xdddd
    v_mov_b32 v1, v7
    v_and_b32 v5, 0xf0, v7
    v_lshrrev_b32 v6, 1, v7
    v_and_b32 v6, 0x100, v6
    v_or_b32 v5, v5, v6
    v_and_b32 v6, 0x100, v7
    v_lshlrev_b32 v6, 8, v6
    v_add_u32 v5, v5, v6
    v_add_u32 v2, 65536, v5
    v_lshrrev_b32 v6, 3, v6
    v_sub_u32 v4, 0x2000, v6
    v_mov_b32 v72, 0
    v_mov_b32 v73, 0
    v_mov_b32 v74, 0
    v_mov_b32 v75, 0
    v_mov_b32 v76, 0
    v_mov_b32 v77, 0
    v_mov_b32 v78, 0
    v_mov_b32 v79, 0
    v_mov_b32 v80, 0
    v_mov_b32 v81, 0
    v_mov_b32 v82, 0
    v_mov_b32 v83, 0
    v_mov_b32 v84, 0
    v_mov_b32 v85, 0
    v_mov_b32 v86, 0
    v_mov_b32 v87, 0
    v_mov_b32 v220, -1
    v_mov_b32 v221, -1
    v_mov_b32 v222, -1
    v_mov_b32 v223, -1
F_b2:
    s_waitcnt lgkmcnt(0)
    s_barrier
    ds_read_b128 v[8:11], v28
    ds_read_b128 v[12:15], v1
    ds_read_b128 v[20:23], v1 offset:1024
    ds_read_b128 v[16:19], v2
    s_waitcnt lgkmcnt(2)
    v_mfma_f32_32x32x16_bf16 v[24:39], v[12:15], v[8:11], 0
    s_waitcnt lgkmcnt(1)
    v_mfma_f32_32x32x16_bf16 v[40:55], v[20:23], v[8:11], 0
    s_nop 10
    v_max3_f32 v5, v24, v25, v26
    v_max3_f32 v5, v5, v27, v28
    v_max3_f32 v5, v5, v29, v30
    v_max3_f32 v5, v5, v31, v32
    v_max3_f32 v5, v5, v33, v34
    v_max3_f32 v5, v5, v35, v36
    v_max3_f32 v5, v5, v37, v38
    v_max_f32 v5, v5, v39
    v_max3_f32 v5, v5, v40, v41
    v_max3_f32 v5, v5, v42, v43
    v_max3_f32 v5, v5, v44, v45
    v_max3_f32 v5, v5, v46, v47
    v_max3_f32 v5, v5, v48, v49
    v_max3_f32 v5, v5, v50, v51
    v_max3_f32 v5, v5, v52, v53
    v_max3_f32 v5, v5, v54, v55
    v_mov_b32 v6, v5
    s_nop 1
    v_permlane32_swap_b32 v5, v6
    s_nop 1
    v_max_f32 v5, v5, v6
    v_sub_f32 v56, 0xc2cc0000, v5
    v_mov_b32 v57, v56
    v_mov_b64 v[58:59], v[56:57]
    v_mov_b64 v[60:61], v[56:57]
    v_mov_b64 v[62:63], v[56:57]
    v_mov_b64 v[64:65], v[56:57]
    v_mov_b64 v[66:67], v[56:57]
    v_mov_b64 v[68:69], v[56:57]
    v_mov_b64 v[70:71], v[56:57]
    s_nop 1
    v_mfma_f32_32x32x16_bf16 v[24:39], v[12:15], v[8:11], v[56:71]
    ds_read_b128 v[12:15], v1 offset:1024
    s_mov_b32 s65, 0
    s_lshl_b32 s58, s51, 3
    s_add_u32 s58, s58, s8
    s_lshl_b32 s58, s58, 5
    s_add_u32 s58, s58, s50
    s_and_b32 s59, s51, 3
    s_or_b32 s59, s59, 4
    s_lshl_b32 s59, s59, 5
    s_xor_b32 s73, s58, s59
    s_lshl_b32 s73, s73, 7
    s_add_u32 s73, s73, 13893632
    s_add_u32 s59, s51, s8
    s_and_b32 s59, s59, 7
    s_lshl_b32 s59, s59, 2
    s_xor_b32 s72, s58, s59
    s_lshl_b32 s72, s72, 10
    s_add_u32 s72, s72, 6291456
    s_cmp_lt_u32 s8, 4
    s_cbranch_scc0 F_roleB
    s_cmp_lg_u32 s15, 2
    s_cbranch_scc1 F_nost2
    buffer_store_dwordx4 v[144:147], v176, s[24:27], s36 offen sc1
    buffer_store_dwordx4 v[148:151], v176, s[24:27], s37 offen sc1
    buffer_store_dwordx4 v[152:155], v176, s[24:27], s38 offen sc1
    buffer_store_dwordx4 v[156:159], v176, s[24:27], s39 offen sc1
    buffer_store_dwordx4 v[160:163], v176, s[24:27], s40 offen sc1
    buffer_store_dwordx4 v[164:167], v176, s[24:27], s41 offen sc1
    buffer_store_dwordx4 v[168:171], v176, s[24:27], s42 offen sc1
    buffer_store_dwordx4 v[172:175], v176, s[24:27], s43 offen sc1
F_nost2:
    s_cmp_lg_u32 s15, 1
    s_cbranch_scc1 F_nofl1
    s_mov_b64 exec, 65535
    s_waitcnt vmcnt(0)
    buffer_store_dwordx2 v[188:189], v190, s[24:27], s14 offen sc1
    s_mov_b64 exec, -1
F_nofl1:
    v_exp_f32 v24, v24
    v_exp_f32 v25, v25
    s_waitcnt lgkmcnt(0)
    ds_read_b128 v[20:23], v2 offset:512
    v_exp_f32 v26, v26
    v_exp_f32 v27, v27
    v_exp_f32 v28, v28
    v_mfma_f32_32x32x16_bf16 v[40:55], v[12:15], v[8:11], v[56:71]
    ds_read_b128 v[12:15], v1 offset:2048
    s_setprio 3
    v_exp_f32 v29, v29
    v_exp_f32 v30, v30
    v_exp_f32 v31, v31
    v_exp_f32 v32, v32
    v_exp_f32 v33, v33
    v_smfmac_f32_32x32x32_bf16 v[72:87], v[16:19], v[24:31], v3
    ds_read_b128 v[16:19], v2 offset:1024
    v_exp_f32 v34, v34
    v_exp_f32 v35, v35
    v_exp_f32 v36, v36
    v_exp_f32 v37, v37
    v_exp_f32 v38, v38
    v_exp_f32 v39, v39
    v_exp_f32 v40, v40
    v_exp_f32 v41, v41
    s_waitcnt lgkmcnt(0)
    v_smfmac_f32_32x32x32_bf16 v[72:87], v[20:23], v[32:39], v3
    ds_read_b128 v[20:23], v2 offset:1536
    v_exp_f32 v42, v42
    v_exp_f32 v43, v43
    v_exp_f32 v44, v44
    v_mfma_f32_32x32x16_bf16 v[24:39], v[12:15], v[8:11], v[56:71]
    ds_read_b128 v[12:15], v1 offset:3072
    v_exp_f32 v45, v45
    v_exp_f32 v46, v46
    v_exp_f32 v47, v47
    v_exp_f32 v48, v48
    v_exp_f32 v49, v49
    v_smfmac_f32_32x32x32_bf16 v[72:87], v[16:19], v[40:47], v3
    ds_read_b128 v[16:19], v2 offset:2048
    v_exp_f32 v50, v50
    v_exp_f32 v51, v51
    v_exp_f32 v52, v52
    v_exp_f32 v53, v53
    v_exp_f32 v54, v54
    v_exp_f32 v55, v55
    v_exp_f32 v24, v24
    v_exp_f32 v25, v25
    s_waitcnt lgkmcnt(0)
    v_smfmac_f32_32x32x32_bf16 v[72:87], v[20:23], v[48:55], v3
    ds_read_b128 v[20:23], v2 offset:2560
    v_exp_f32 v26, v26
    v_exp_f32 v27, v27
    v_exp_f32 v28, v28
    v_mfma_f32_32x32x16_bf16 v[40:55], v[12:15], v[8:11], v[56:71]
    ds_read_b128 v[12:15], v1 offset:4096
    v_exp_f32 v29, v29
    v_exp_f32 v30, v30
    v_exp_f32 v31, v31
    v_exp_f32 v32, v32
    v_exp_f32 v33, v33
    v_smfmac_f32_32x32x32_bf16 v[72:87], v[16:19], v[24:31], v3
    ds_read_b128 v[16:19], v2 offset:3072
    v_exp_f32 v34, v34
    v_exp_f32 v35, v35
    v_exp_f32 v36, v36
    v_exp_f32 v37, v37
    v_exp_f32 v38, v38
    v_exp_f32 v39, v39
    s_cmp_lg_u32 s15, 3
    s_cbranch_scc1 F_nost3
    buffer_store_dwordx4 v[144:147], v176, s[24:27], s36 offen sc1
    buffer_store_dwordx4 v[148:151], v176, s[24:27], s37 offen sc1
    buffer_store_dwordx4 v[152:155], v176, s[24:27], s38 offen sc1
    buffer_store_dwordx4 v[156:159], v176, s[24:27], s39 offen sc1
    buffer_store_dwordx4 v[160:163], v176, s[24:27], s40 offen sc1
    buffer_store_dwordx4 v[164:167], v176, s[24:27], s41 offen sc1
    buffer_store_dwordx4 v[168:171], v176, s[24:27], s42 offen sc1
    buffer_store_dwordx4 v[172:175], v176, s[24:27], s43 offen sc1
F_nost3:
    v_exp_f32 v40, v40
    v_exp_f32 v41, v41
    s_waitcnt lgkmcnt(0)
    v_smfmac_f32_32x32x32_bf16 v[72:87], v[20:23], v[32:39], v3
    ds_read_b128 v[20:23], v2 offset:3584
    v_exp_f32 v42, v42
    v_exp_f32 v43, v43
    v_exp_f32 v44, v44
    v_mfma_f32_32x32x16_bf16 v[24:39], v[12:15], v[8:11], v[56:71]
    ds_read_b128 v[12:15], v1 offset:5120
    v_exp_f32 v45, v45
    v_exp_f32 v46, v46
    v_exp_f32 v47, v47
    v_exp_f32 v48, v48
    v_exp_f32 v49, v49
    v_smfmac_f32_32x32x32_bf16 v[72:87], v[16:19], v[40:47], v3
    ds_read_b128 v[16:19], v2 offset:4096
    v_exp_f32 v50, v50
    v_exp_f32 v51, v51
    v_exp_f32 v52, v52
    v_exp_f32 v53, v53
    v_exp_f32 v54, v54
    v_exp_f32 v55, v55
    v_exp_f32 v24, v24
    v_exp_f32 v25, v25
    s_waitcnt lgkmcnt(0)
    v_smfmac_f32_32x32x32_bf16 v[72:87], v[20:23], v[48:55], v3
    ds_read_b128 v[20:23], v2 offset:4608
    v_exp_f32 v26, v26
    v_exp_f32 v27, v27
    v_exp_f32 v28, v28
    v_mfma_f32_32x32x16_bf16 v[40:55], v[12:15], v[8:11], v[56:71]
    ds_read_b128 v[12:15], v1 offset:6144
    v_exp_f32 v29, v29
    v_exp_f32 v30, v30
    v_exp_f32 v31, v31
    v_exp_f32 v32, v32
    v_exp_f32 v33, v33
    v_smfmac_f32_32x32x32_bf16 v[72:87], v[16:19], v[24:31], v3
    ds_read_b128 v[16:19], v2 offset:5120
    v_exp_f32 v34, v34
    v_exp_f32 v35, v35
    v_exp_f32 v36, v36
    v_exp_f32 v37, v37
    v_exp_f32 v38, v38
    v_exp_f32 v39, v39
    v_exp_f32 v40, v40
    v_exp_f32 v41, v41
    s_waitcnt lgkmcnt(0)
    v_smfmac_f32_32x32x32_bf16 v[72:87], v[20:23], v[32:39], v3
    ds_read_b128 v[20:23], v2 offset:5632
    v_exp_f32 v42, v42
    v_exp_f32 v43, v43
    v_exp_f32 v44, v44
    v_mfma_f32_32x32x16_bf16 v[24:39], v[12:15], v[8:11], v[56:71]
    ds_read_b128 v[12:15], v1 offset:7168
    v_exp_f32 v45, v45
    v_exp_f32 v46, v46
    v_exp_f32 v47, v47
    v_exp_f32 v48, v48
    v_exp_f32 v49, v49
    v_smfmac_f32_32x32x32_bf16 v[72:87], v[16:19], v[40:47], v3
    ds_read_b128 v[16:19], v2 offset:6144
    v_exp_f32 v50, v50
    v_exp_f32 v51, v51
    v_exp_f32 v52, v52
    v_exp_f32 v53, v53
    v_exp_f32 v54, v54
    v_exp_f32 v55, v55
    v_exp_f32 v24, v24
    v_exp_f32 v25, v25
    s_waitcnt lgkmcnt(0)
    v_smfmac_f32_32x32x32_bf16 v[72:87], v[20:23], v[48:55], v3
    ds_read_b128 v[20:23], v2 offset:6656
    v_exp_f32 v26, v26
    v_exp_f32 v27, v27
    v_exp_f32 v28, v28
    v_mfma_f32_32x32x16_bf16 v[40:55], v[12:15], v[8:11], v[56:71]
    ds_read_b128 v[12:15], v1 offset:8192
    v_exp_f32 v29, v29
    v_exp_f32 v30, v30
    v_exp_f32 v31, v31
    v_exp_f32 v32, v32
    v_exp_f32 v33, v33
    v_smfmac_f32_32x32x32_bf16 v[72:87], v[16:19], v[24:31], v3
    ds_read_b128 v[16:19], v2 offset:7168
    v_exp_f32 v34, v34
    v_exp_f32 v35, v35
    v_exp_f32 v36, v36
    v_exp_f32 v37, v37
    v_exp_f32 v38, v38
    v_exp_f32 v39, v39
    v_exp_f32 v40, v40
    v_exp_f32 v41, v41
    s_waitcnt lgkmcnt(0)
    v_smfmac_f32_32x32x32_bf16 v[72:87], v[20:23], v[32:39], v3
    ds_read_b128 v[20:23], v2 offset:7680
    v_exp_f32 v42, v42
    v_exp_f32 v43, v43
    v_exp_f32 v44, v44
    v_mfma_f32_32x32x16_bf16 v[24:39], v[12:15], v[8:11], v[56:71]
    ds_read_b128 v[12:15], v1 offset:9216
    v_exp_f32 v45, v45
    v_exp_f32 v46, v46
    v_exp_f32 v47, v47
    v_exp_f32 v48, v48
    v_exp_f32 v49, v49
    v_smfmac_f32_32x32x32_bf16 v[72:87], v[16:19], v[40:47], v3
    ds_read_b128 v[16:19], v2 offset:8192
    v_exp_f32 v50, v50
    v_exp_f32 v51, v51
    v_exp_f32 v52, v52
    v_exp_f32 v53, v53
    v_exp_f32 v54, v54
    v_exp_f32 v55, v55
    v_add_u32 v2, v4, v2
    s_cmp_lg_u32 s15, 2
    s_cbranch_scc1 F_nofl2
    s_mov_b64 exec, 65535
    s_waitcnt vmcnt(0)
    buffer_store_dwordx2 v[188:189], v190, s[24:27], s14 offen sc1
    s_mov_b64 exec, -1
F_nofl2:
    v_exp_f32 v24, v24
    v_exp_f32 v25, v25
    s_waitcnt lgkmcnt(0)
    v_smfmac_f32_32x32x32_bf16 v[72:87], v[20:23], v[48:55], v3
    ds_read_b128 v[20:23], v2 offset:512
    v_exp_f32 v26, v26
    v_exp_f32 v27, v27
    v_exp_f32 v28, v28
    v_mfma_f32_32x32x16_bf16 v[40:55], v[12:15], v[8:11], v[56:71]
    ds_read_b128 v[12:15], v1 offset:10240
    s_setprio 2
    v_exp_f32 v29, v29
    v_exp_f32 v30, v30
    v_exp_f32 v31, v31
    v_exp_f32 v32, v32
    v_exp_f32 v33, v33
    v_smfmac_f32_32x32x32_bf16 v[72:87], v[16:19], v[24:31], v3
    ds_read_b128 v[16:19], v2 offset:1024
    v_exp_f32 v34, v34
    v_exp_f32 v35, v35
    v_exp_f32 v36, v36
    v_exp_f32 v37, v37
    v_exp_f32 v38, v38
    v_exp_f32 v39, v39
    v_exp_f32 v40, v40
    v_exp_f32 v41, v41
    s_waitcnt lgkmcnt(0)
    v_smfmac_f32_32x32x32_bf16 v[72:87], v[20:23], v[32:39], v3
    ds_read_b128 v[20:23], v2 offset:1536
    v_exp_f32 v42, v42
    v_exp_f32 v43, v43
    v_exp_f32 v44, v44
    v_mfma_f32_32x32x16_bf16 v[24:39], v[12:15], v[8:11], v[56:71]
    ds_read_b128 v[12:15], v1 offset:11264
    v_exp_f32 v45, v45
    v_exp_f32 v46, v46
    v_exp_f32 v47, v47
    v_exp_f32 v48, v48
    v_exp_f32 v49, v49
    v_smfmac_f32_32x32x32_bf16 v[72:87], v[16:19], v[40:47], v3
    ds_read_b128 v[16:19], v2 offset:2048
    v_exp_f32 v50, v50
    v_exp_f32 v51, v51
    v_exp_f32 v52, v52
    v_exp_f32 v53, v53
    v_exp_f32 v54, v54
    v_exp_f32 v55, v55
    v_exp_f32 v24, v24
    v_exp_f32 v25, v25
    s_waitcnt lgkmcnt(0)
    v_smfmac_f32_32x32x32_bf16 v[72:87], v[20:23], v[48:55], v3
    ds_read_b128 v[20:23], v2 offset:2560
    v_exp_f32 v26, v26
    v_exp_f32 v27, v27
    v_exp_f32 v28, v28
    v_mfma_f32_32x32x16_bf16 v[40:55], v[12:15], v[8:11], v[56:71]
    ds_read_b128 v[12:15], v1 offset:12288
    v_exp_f32 v29, v29
    v_exp_f32 v30, v30
    v_exp_f32 v31, v31
    v_exp_f32 v32, v32
    v_exp_f32 v33, v33
    v_smfmac_f32_32x32x32_bf16 v[72:87], v[16:19], v[24:31], v3
    ds_read_b128 v[16:19], v2 offset:3072
    v_exp_f32 v34, v34
    v_exp_f32 v35, v35
    v_exp_f32 v36, v36
    v_exp_f32 v37, v37
    v_exp_f32 v38, v38
    v_exp_f32 v39, v39
    v_exp_f32 v40, v40
    v_exp_f32 v41, v41
    s_waitcnt lgkmcnt(0)
    v_smfmac_f32_32x32x32_bf16 v[72:87], v[20:23], v[32:39], v3
    ds_read_b128 v[20:23], v2 offset:3584
    v_exp_f32 v42, v42
    v_exp_f32 v43, v43
    v_exp_f32 v44, v44
    v_mfma_f32_32x32x16_bf16 v[24:39], v[12:15], v[8:11], v[56:71]
    ds_read_b128 v[12:15], v1 offset:13312
    v_exp_f32 v45, v45
    v_exp_f32 v46, v46
    v_exp_f32 v47, v47
    v_exp_f32 v48, v48
    v_exp_f32 v49, v49
    v_smfmac_f32_32x32x32_bf16 v[72:87], v[16:19], v[40:47], v3
    ds_read_b128 v[16:19], v2 offset:4096
    v_exp_f32 v50, v50
    v_exp_f32 v51, v51
    v_exp_f32 v52, v52
    v_exp_f32 v53, v53
    v_exp_f32 v54, v54
    v_exp_f32 v55, v55
    v_exp_f32 v24, v24
    v_exp_f32 v25, v25
    s_waitcnt lgkmcnt(0)
    v_smfmac_f32_32x32x32_bf16 v[72:87], v[20:23], v[48:55], v3
    ds_read_b128 v[20:23], v2 offset:4608
    v_exp_f32 v26, v26
    v_exp_f32 v27, v27
    v_exp_f32 v28, v28
    v_mfma_f32_32x32x16_bf16 v[40:55], v[12:15], v[8:11], v[56:71]
    ds_read_b128 v[12:15], v1 offset:14336
    s_setprio 1
    v_exp_f32 v29, v29
    v_exp_f32 v30, v30
    v_exp_f32 v31, v31
    v_exp_f32 v32, v32
    v_exp_f32 v33, v33
    v_smfmac_f32_32x32x32_bf16 v[72:87], v[16:19], v[24:31], v3
    ds_read_b128 v[16:19], v2 offset:5120
    v_exp_f32 v34, v34
    v_exp_f32 v35, v35
    v_exp_f32 v36, v36
    v_exp_f32 v37, v37
    v_exp_f32 v38, v38
    v_exp_f32 v39, v39
    v_exp_f32 v40, v40
    v_exp_f32 v41, v41
    s_waitcnt lgkmcnt(0)
    v_smfmac_f32_32x32x32_bf16 v[72:87], v[20:23], v[32:39], v3
    ds_read_b128 v[20:23], v2 offset:5632
    v_exp_f32 v42, v42
    v_exp_f32 v43, v43
    v_exp_f32 v44, v44
    v_mfma_f32_32x32x16_bf16 v[24:39], v[12:15], v[8:11], v[56:71]
    ds_read_b128 v[12:15], v1 offset:15360
    v_exp_f32 v45, v45
    v_exp_f32 v46, v46
    v_exp_f32 v47, v47
    v_exp_f32 v48, v48
    v_exp_f32 v49, v49
    v_smfmac_f32_32x32x32_bf16 v[72:87], v[16:19], v[40:47], v3
    ds_read_b128 v[16:19], v2 offset:6144
    v_exp_f32 v50, v50
    v_exp_f32 v51, v51
    v_exp_f32 v52, v52
    v_exp_f32 v53, v53
    v_exp_f32 v54, v54
    v_exp_f32 v55, v55
    s_waitcnt vmcnt(0)
    s_barrier
    v_exp_f32 v24, v24
    v_exp_f32 v25, v25
    s_waitcnt lgkmcnt(0)
    v_smfmac_f32_32x32x32_bf16 v[72:87], v[20:23], v[48:55], v3
    ds_read_b128 v[20:23], v2 offset:6656
    s_mov_b64 exec, s[70:71]
    buffer_store_dwordx2 v[188:189], v187, s[24:27], 0 offen sc1
    s_mov_b64 exec, -1
    v_exp_f32 v26, v26
    v_exp_f32 v27, v27
    v_exp_f32 v28, v28
    v_mfma_f32_32x32x16_bf16 v[40:55], v[12:15], v[8:11], v[56:71]
    ds_read_b128 v[12:15], v1 offset:16384
    s_setprio 3
    v_exp_f32 v29, v29
    v_exp_f32 v30, v30
    v_exp_f32 v31, v31
    v_exp_f32 v32, v32
    v_exp_f32 v33, v33
    v_smfmac_f32_32x32x32_bf16 v[72:87], v[16:19], v[24:31], v3
    ds_read_b128 v[16:19], v2 offset:7168
    v_exp_f32 v34, v34
    v_exp_f32 v35, v35
    v_exp_f32 v36, v36
    v_exp_f32 v37, v37
    v_exp_f32 v38, v38
    v_exp_f32 v39, v39
    v_exp_f32 v40, v40
    v_exp_f32 v41, v41
    s_waitcnt lgkmcnt(0)
    v_smfmac_f32_32x32x32_bf16 v[72:87], v[20:23], v[32:39], v3
    ds_read_b128 v[20:23], v2 offset:7680
    v_exp_f32 v42, v42
    v_exp_f32 v43, v43
    v_exp_f32 v44, v44
    v_mfma_f32_32x32x16_bf16 v[24:39], v[12:15], v[8:11], v[56:71]
    ds_read_b128 v[12:15], v1 offset:17408
    v_exp_f32 v45, v45
    v_exp_f32 v46, v46
    v_exp_f32 v47, v47
    v_exp_f32 v48, v48
    v_exp_f32 v49, v49
    v_smfmac_f32_32x32x32_bf16 v[72:87], v[16:19], v[40:47], v3
    ds_read_b128 v[16:19], v2 offset:8192
    v_exp_f32 v50, v50
    v_exp_f32 v51, v51
    v_exp_f32 v52, v52
    v_exp_f32 v53, v53
    v_exp_f32 v54, v54
    v_exp_f32 v55, v55
    v_add_u32 v2, v4, v2
    v_exp_f32 v24, v24
    v_exp_f32 v25, v25
    s_waitcnt lgkmcnt(0)
    v_smfmac_f32_32x32x32_bf16 v[72:87], v[20:23], v[48:55], v3
    ds_read_b128 v[20:23], v2 offset:512
    v_exp_f32 v26, v26
    v_exp_f32 v27, v27
    v_exp_f32 v28, v28
    v_mfma_f32_32x32x16_bf16 v[40:55], v[12:15], v[8:11], v[56:71]
    ds_read_b128 v[12:15], v1 offset:18432
    v_exp_f32 v29, v29
    v_exp_f32 v30, v30
    v_exp_f32 v31, v31
    v_exp_f32 v32, v32
    v_exp_f32 v33, v33
    v_smfmac_f32_32x32x32_bf16 v[72:87], v[16:19], v[24:31], v3
    ds_read_b128 v[16:19], v2 offset:1024
    v_exp_f32 v34, v34
    v_exp_f32 v35, v35
    v_exp_f32 v36, v36
    v_exp_f32 v37, v37
    v_exp_f32 v38, v38
    v_exp_f32 v39, v39
    v_exp_f32 v40, v40
    v_exp_f32 v41, v41
    s_waitcnt lgkmcnt(0)
    v_smfmac_f32_32x32x32_bf16 v[72:87], v[20:23], v[32:39], v3
    ds_read_b128 v[20:23], v2 offset:1536
    v_exp_f32 v42, v42
    v_exp_f32 v43, v43
    v_exp_f32 v44, v44
    v_mfma_f32_32x32x16_bf16 v[24:39], v[12:15], v[8:11], v[56:71]
    ds_read_b128 v[12:15], v1 offset:19456
    v_exp_f32 v45, v45
    v_exp_f32 v46, v46
    v_exp_f32 v47, v47
    v_exp_f32 v48, v48
    v_exp_f32 v49, v49
    v_smfmac_f32_32x32x32_bf16 v[72:87], v[16:19], v[40:47], v3
    ds_read_b128 v[16:19], v2 offset:2048
    buffer_store_dwordx4 v[220:223], v7, s[24:27], s72 offen sc1
    v_exp_f32 v50, v50
    v_exp_f32 v51, v51
    v_exp_f32 v52, v52
    v_exp_f32 v53, v53
    v_exp_f32 v54, v54
    v_exp_f32 v55, v55
    v_exp_f32 v24, v24
    v_exp_f32 v25, v25
    s_waitcnt lgkmcnt(0)
    v_smfmac_f32_32x32x32_bf16 v[72:87], v[20:23], v[48:55], v3
    ds_read_b128 v[20:23], v2 offset:2560
    v_exp_f32 v26, v26
    v_exp_f32 v27, v27
    v_exp_f32 v28, v28
    v_mfma_f32_32x32x16_bf16 v[40:55], v[12:15], v[8:11], v[56:71]
    ds_read_b128 v[12:15], v1 offset:20480
    v_exp_f32 v29, v29
    v_exp_f32 v30, v30
    v_exp_f32 v31, v31
    v_exp_f32 v32, v32
    v_exp_f32 v33, v33
    v_smfmac_f32_32x32x32_bf16 v[72:87], v[16:19], v[24:31], v3
    ds_read_b128 v[16:19], v2 offset:3072
    v_exp_f32 v34, v34
    v_exp_f32 v35, v35
    v_exp_f32 v36, v36
    v_exp_f32 v37, v37
    v_exp_f32 v38, v38
    v_exp_f32 v39, v39
    v_exp_f32 v40, v40
    v_exp_f32 v41, v41
    s_waitcnt lgkmcnt(0)
    v_smfmac_f32_32x32x32_bf16 v[72:87], v[20:23], v[32:39], v3
    ds_read_b128 v[20:23], v2 offset:3584
    v_exp_f32 v42, v42
    v_exp_f32 v43, v43
    v_exp_f32 v44, v44
    v_mfma_f32_32x32x16_bf16 v[24:39], v[12:15], v[8:11], v[56:71]
    ds_read_b128 v[12:15], v1 offset:21504
    v_exp_f32 v45, v45
    v_exp_f32 v46, v46
    v_exp_f32 v47, v47
    v_exp_f32 v48, v48
    v_exp_f32 v49, v49
    v_smfmac_f32_32x32x32_bf16 v[72:87], v[16:19], v[40:47], v3
    ds_read_b128 v[16:19], v2 offset:4096
    v_exp_f32 v50, v50
    v_exp_f32 v51, v51
    v_exp_f32 v52, v52
    v_exp_f32 v53, v53
    v_exp_f32 v54, v54
    v_exp_f32 v55, v55
    v_exp_f32 v24, v24
    v_exp_f32 v25, v25
    s_waitcnt lgkmcnt(0)
    v_smfmac_f32_32x32x32_bf16 v[72:87], v[20:23], v[48:55], v3
    ds_read_b128 v[20:23], v2 offset:4608
    v_exp_f32 v26, v26
    v_exp_f32 v27, v27
    v_exp_f32 v28, v28
    v_mfma_f32_32x32x16_bf16 v[40:55], v[12:15], v[8:11], v[56:71]
    ds_read_b128 v[12:15], v1 offset:22528
    v_exp_f32 v29, v29
    v_exp_f32 v30, v30
    v_exp_f32 v31, v31
    v_exp_f32 v32, v32
    v_exp_f32 v33, v33
    v_smfmac_f32_32x32x32_bf16 v[72:87], v[16:19], v[24:31], v3
    ds_read_b128 v[16:19], v2 offset:5120
    v_exp_f32 v34, v34
    v_exp_f32 v35, v35
    v_exp_f32 v36, v36
    v_exp_f32 v37, v37
    v_exp_f32 v38, v38
    v_exp_f32 v39, v39
    v_exp_f32 v40, v40
    v_exp_f32 v41, v41
    s_waitcnt lgkmcnt(0)
    v_smfmac_f32_32x32x32_bf16 v[72:87], v[20:23], v[32:39], v3
    ds_read_b128 v[20:23], v2 offset:5632
    v_exp_f32 v42, v42
    v_exp_f32 v43, v43
    v_exp_f32 v44, v44
    v_mfma_f32_32x32x16_bf16 v[24:39], v[12:15], v[8:11], v[56:71]
    ds_read_b128 v[12:15], v1 offset:23552
    v_exp_f32 v45, v45
    v_exp_f32 v46, v46
    v_exp_f32 v47, v47
    v_exp_f32 v48, v48
    v_exp_f32 v49, v49
    v_smfmac_f32_32x32x32_bf16 v[72:87], v[16:19], v[40:47], v3
    ds_read_b128 v[16:19], v2 offset:6144
    v_exp_f32 v50, v50
    v_exp_f32 v51, v51
    v_exp_f32 v52, v52
    v_exp_f32 v53, v53
    v_exp_f32 v54, v54
    v_exp_f32 v55, v55
    v_exp_f32 v24, v24
    v_exp_f32 v25, v25
    s_waitcnt lgkmcnt(0)
    v_smfmac_f32_32x32x32_bf16 v[72:87], v[20:23], v[48:55], v3
    ds_read_b128 v[20:23], v2 offset:6656
    v_exp_f32 v26, v26
    v_exp_f32 v27, v27
    v_exp_f32 v28, v28
    v_mfma_f32_32x32x16_bf16 v[40:55], v[12:15], v[8:11], v[56:71]
    ds_read_b128 v[12:15], v1 offset:24576
    v_exp_f32 v29, v29
    v_exp_f32 v30, v30
    v_exp_f32 v31, v31
    v_exp_f32 v32, v32
    v_exp_f32 v33, v33
    v_smfmac_f32_32x32x32_bf16 v[72:87], v[16:19], v[24:31], v3
    ds_read_b128 v[16:19], v2 offset:7168
    v_exp_f32 v34, v34
    v_exp_f32 v35, v35
    v_exp_f32 v36, v36
    v_exp_f32 v37, v37
    v_exp_f32 v38, v38
    v_exp_f32 v39, v39
    v_exp_f32 v40, v40
    v_exp_f32 v41, v41
    s_waitcnt lgkmcnt(0)
    v_smfmac_f32_32x32x32_bf16 v[72:87], v[20:23], v[32:39], v3
    ds_read_b128 v[20:23], v2 offset:7680
    v_exp_f32 v42, v42
    v_exp_f32 v43, v43
    v_exp_f32 v44, v44
    v_mfma_f32_32x32x16_bf16 v[24:39], v[12:15], v[8:11], v[56:71]
    ds_read_b128 v[12:15], v1 offset:25600
    s_setprio 2
    v_exp_f32 v45, v45
    v_exp_f32 v46, v46
    v_exp_f32 v47, v47
    v_exp_f32 v48, v48
    v_exp_f32 v49, v49
    v_smfmac_f32_32x32x32_bf16 v[72:87], v[16:19], v[40:47], v3
    ds_read_b128 v[16:19], v2 offset:8192
    v_exp_f32 v50, v50
    v_exp_f32 v51, v51
    v_exp_f32 v52, v52
    v_exp_f32 v53, v53
    v_exp_f32 v54, v54
    v_exp_f32 v55, v55
    v_add_u32 v2, v4, v2
    v_exp_f32 v24, v24
    v_exp_f32 v25, v25
    s_waitcnt lgkmcnt(0)
    v_smfmac_f32_32x32x32_bf16 v[72:87], v[20:23], v[48:55], v3
    ds_read_b128 v[20:23], v2 offset:512
    v_exp_f32 v26, v26
    v_exp_f32 v27, v27
    v_exp_f32 v28, v28
    v_mfma_f32_32x32x16_bf16 v[40:55], v[12:15], v[8:11], v[56:71]
    ds_read_b128 v[12:15], v1 offset:26624
    v_exp_f32 v29, v29
    v_exp_f32 v30, v30
    v_exp_f32 v31, v31
    v_exp_f32 v32, v32
    v_exp_f32 v33, v33
    v_smfmac_f32_32x32x32_bf16 v[72:87], v[16:19], v[24:31], v3
    ds_read_b128 v[16:19], v2 offset:1024
    v_exp_f32 v34, v34
    v_exp_f32 v35, v35
    v_exp_f32 v36, v36
    v_exp_f32 v37, v37
    v_exp_f32 v38, v38
    v_exp_f32 v39, v39
    v_exp_f32 v40, v40
    v_exp_f32 v41, v41
    s_waitcnt lgkmcnt(0)
    v_smfmac_f32_32x32x32_bf16 v[72:87], v[20:23], v[32:39], v3
    ds_read_b128 v[20:23], v2 offset:1536
    v_exp_f32 v42, v42
    v_exp_f32 v43, v43
    v_exp_f32 v44, v44
    v_mfma_f32_32x32x16_bf16 v[24:39], v[12:15], v[8:11], v[56:71]
    ds_read_b128 v[12:15], v1 offset:27648
    v_exp_f32 v45, v45
    v_exp_f32 v46, v46
    v_exp_f32 v47, v47
    v_exp_f32 v48, v48
    v_exp_f32 v49, v49
    v_smfmac_f32_32x32x32_bf16 v[72:87], v[16:19], v[40:47], v3
    ds_read_b128 v[16:19], v2 offset:2048
    v_exp_f32 v50, v50
    v_exp_f32 v51, v51
    v_exp_f32 v52, v52
    v_exp_f32 v53, v53
    v_exp_f32 v54, v54
    v_exp_f32 v55, v55
    v_exp_f32 v24, v24
    v_exp_f32 v25, v25
    s_waitcnt lgkmcnt(0)
    v_smfmac_f32_32x32x32_bf16 v[72:87], v[20:23], v[48:55], v3
    ds_read_b128 v[20:23], v2 offset:2560
    v_exp_f32 v26, v26
    v_exp_f32 v27, v27
    v_exp_f32 v28, v28
    v_mfma_f32_32x32x16_bf16 v[40:55], v[12:15], v[8:11], v[56:71]
    ds_read_b128 v[12:15], v1 offset:28672
    v_exp_f32 v29, v29
    v_exp_f32 v30, v30
    v_exp_f32 v31, v31
    v_exp_f32 v32, v32
    v_exp_f32 v33, v33
    v_smfmac_f32_32x32x32_bf16 v[72:87], v[16:19], v[24:31], v3
    ds_read_b128 v[16:19], v2 offset:3072
    v_exp_f32 v34, v34
    v_exp_f32 v35, v35
    v_exp_f32 v36, v36
    v_exp_f32 v37, v37
    v_exp_f32 v38, v38
    v_exp_f32 v39, v39
    v_exp_f32 v40, v40
    v_exp_f32 v41, v41
    s_waitcnt lgkmcnt(0)
    v_smfmac_f32_32x32x32_bf16 v[72:87], v[20:23], v[32:39], v3
    ds_read_b128 v[20:23], v2 offset:3584
    v_exp_f32 v42, v42
    v_exp_f32 v43, v43
    v_exp_f32 v44, v44
    v_mfma_f32_32x32x16_bf16 v[24:39], v[12:15], v[8:11], v[56:71]
    ds_read_b128 v[12:15], v1 offset:29696
    s_setprio 1
    v_exp_f32 v45, v45
    v_exp_f32 v46, v46
    v_exp_f32 v47, v47
    v_exp_f32 v48, v48
    v_exp_f32 v49, v49
    v_smfmac_f32_32x32x32_bf16 v[72:87], v[16:19], v[40:47], v3
    ds_read_b128 v[16:19], v2 offset:4096
    v_exp_f32 v50, v50
    v_exp_f32 v51, v51
    v_exp_f32 v52, v52
    v_exp_f32 v53, v53
    v_exp_f32 v54, v54
    v_exp_f32 v55, v55
    v_exp_f32 v24, v24
    v_exp_f32 v25, v25
    s_waitcnt lgkmcnt(0)
    v_smfmac_f32_32x32x32_bf16 v[72:87], v[20:23], v[48:55], v3
    ds_read_b128 v[20:23], v2 offset:4608
    v_exp_f32 v26, v26
    v_exp_f32 v27, v27
    v_exp_f32 v28, v28
    v_mfma_f32_32x32x16_bf16 v[40:55], v[12:15], v[8:11], v[56:71]
    ds_read_b128 v[12:15], v1 offset:30720
    v_exp_f32 v29, v29
    v_exp_f32 v30, v30
    v_exp_f32 v31, v31
    v_exp_f32 v32, v32
    v_exp_f32 v33, v33
    v_smfmac_f32_32x32x32_bf16 v[72:87], v[16:19], v[24:31], v3
    ds_read_b128 v[16:19], v2 offset:5120
    v_exp_f32 v34, v34
    v_exp_f32 v35, v35
    v_exp_f32 v36, v36
    v_exp_f32 v37, v37
    v_exp_f32 v38, v38
    v_exp_f32 v39, v39
    v_exp_f32 v40, v40
    v_exp_f32 v41, v41
    s_waitcnt lgkmcnt(0)
    v_smfmac_f32_32x32x32_bf16 v[72:87], v[20:23], v[32:39], v3
    ds_read_b128 v[20:23], v2 offset:5632
    v_exp_f32 v42, v42
    v_exp_f32 v43, v43
    v_exp_f32 v44, v44
    v_mfma_f32_32x32x16_bf16 v[24:39], v[12:15], v[8:11], v[56:71]
    ds_read_b128 v[12:15], v1 offset:31744
    v_exp_f32 v45, v45
    v_exp_f32 v46, v46
    v_exp_f32 v47, v47
    v_exp_f32 v48, v48
    v_exp_f32 v49, v49
    v_smfmac_f32_32x32x32_bf16 v[72:87], v[16:19], v[40:47], v3
    ds_read_b128 v[16:19], v2 offset:6144
    v_exp_f32 v50, v50
    v_exp_f32 v51, v51
    v_exp_f32 v52, v52
    v_exp_f32 v53, v53
    v_exp_f32 v54, v54
    v_exp_f32 v55, v55
    s_waitcnt vmcnt(0)
    s_barrier
    v_exp_f32 v24, v24
    v_exp_f32 v25, v25
    s_waitcnt lgkmcnt(0)
    v_smfmac_f32_32x32x32_bf16 v[72:87], v[20:23], v[48:55], v3
    ds_read_b128 v[20:23], v2 offset:6656
    v_exp_f32 v26, v26
    v_exp_f32 v27, v27
    v_exp_f32 v28, v28
    v_mfma_f32_32x32x16_bf16 v[40:55], v[12:15], v[8:11], v[56:71]
    ds_read_b128 v[12:15], v1 offset:32768
    s_add_u32 s59, s63, 28672
    buffer_load_dwordx4 v[200:203], v7, s[24:27], s59 offen offset:0 sc1
    s_setprio 3
    v_exp_f32 v29, v29
    v_exp_f32 v30, v30
    v_exp_f32 v31, v31
    v_exp_f32 v32, v32
    v_exp_f32 v33, v33
    v_smfmac_f32_32x32x32_bf16 v[72:87], v[16:19], v[24:31], v3
    ds_read_b128 v[16:19], v2 offset:7168
    s_add_u32 s58, s63, 0
    buffer_load_dwordx4 v[88:91], v7, s[24:27], s58 offen offset:0 sc1
    v_exp_f32 v34, v34
    v_exp_f32 v35, v35
    v_exp_f32 v36, v36
    v_exp_f32 v37, v37
    v_exp_f32 v38, v38
    v_exp_f32 v39, v39
    v_exp_f32 v40, v40
    v_exp_f32 v41, v41
    s_waitcnt lgkmcnt(0)
    v_smfmac_f32_32x32x32_bf16 v[72:87], v[20:23], v[32:39], v3
    ds_read_b128 v[20:23], v2 offset:7680
    v_exp_f32 v42, v42
    v_exp_f32 v43, v43
    v_exp_f32 v44, v44
    v_mfma_f32_32x32x16_bf16 v[24:39], v[12:15], v[8:11], v[56:71]
    ds_read_b128 v[12:15], v1 offset:33792
    buffer_load_dwordx4 v[204:207], v7, s[24:27], s59 offen offset:1024 sc1
    v_exp_f32 v45, v45
    v_exp_f32 v46, v46
    v_exp_f32 v47, v47
    v_exp_f32 v48, v48
    v_exp_f32 v49, v49
    v_smfmac_f32_32x32x32_bf16 v[72:87], v[16:19], v[40:47], v3
    ds_read_b128 v[16:19], v2 offset:8192
    buffer_load_dwordx4 v[92:95], v7, s[24:27], s58 offen offset:1024 sc1
    v_exp_f32 v50, v50
    v_exp_f32 v51, v51
    v_exp_f32 v52, v52
    v_exp_f32 v53, v53
    v_exp_f32 v54, v54
    v_exp_f32 v55, v55
    v_add_u32 v2, v4, v2
    v_exp_f32 v24, v24
    v_exp_f32 v25, v25
    s_waitcnt lgkmcnt(0)
    v_smfmac_f32_32x32x32_bf16 v[72:87], v[20:23], v[48:55], v3
    ds_read_b128 v[20:23], v2 offset:512
    v_exp_f32 v26, v26
    v_exp_f32 v27, v27
    v_exp_f32 v28, v28
    v_mfma_f32_32x32x16_bf16 v[40:55], v[12:15], v[8:11], v[56:71]
    ds_read_b128 v[12:15], v1 offset:34816
    buffer_load_dwordx4 v[208:211], v7, s[24:27], s59 offen offset:2048 sc1
    v_exp_f32 v29, v29
    v_exp_f32 v30, v30
    v_exp_f32 v31, v31
    v_exp_f32 v32, v32
    v_exp_f32 v33, v33
    v_smfmac_f32_32x32x32_bf16 v[72:87], v[16:19], v[24:31], v3
    ds_read_b128 v[16:19], v2 offset:1024
    buffer_load_dwordx4 v[96:99], v7, s[24:27], s58 offen offset:2048 sc1
    v_exp_f32 v34, v34
    v_exp_f32 v35, v35
    v_exp_f32 v36, v36
    v_exp_f32 v37, v37
    v_exp_f32 v38, v38
    v_exp_f32 v39, v39
    v_exp_f32 v40, v40
    v_exp_f32 v41, v41
    s_waitcnt lgkmcnt(0)
    v_smfmac_f32_32x32x32_bf16 v[72:87], v[20:23], v[32:39], v3
    ds_read_b128 v[20:23], v2 offset:1536
    v_exp_f32 v42, v42
    v_exp_f32 v43, v43
    v_exp_f32 v44, v44
    v_mfma_f32_32x32x16_bf16 v[24:39], v[12:15], v[8:11], v[56:71]
    ds_read_b128 v[12:15], v1 offset:35840
    buffer_load_dwordx4 v[212:215], v7, s[24:27], s59 offen offset:3072 sc1
    v_exp_f32 v45, v45
    v_exp_f32 v46, v46
    v_exp_f32 v47, v47
    v_exp_f32 v48, v48
    v_exp_f32 v49, v49
    v_smfmac_f32_32x32x32_bf16 v[72:87], v[16:19], v[40:47], v3
    ds_read_b128 v[16:19], v2 offset:2048
    buffer_load_dwordx4 v[100:103], v7, s[24:27], s58 offen offset:3072 sc1
    v_exp_f32 v50, v50
    v_exp_f32 v51, v51
    v_exp_f32 v52, v52
    v_exp_f32 v53, v53
    v_exp_f32 v54, v54
    v_exp_f32 v55, v55
    v_exp_f32 v24, v24
    v_exp_f32 v25, v25
    s_waitcnt lgkmcnt(0)
    v_smfmac_f32_32x32x32_bf16 v[72:87], v[20:23], v[48:55], v3
    ds_read_b128 v[20:23], v2 offset:2560
    v_exp_f32 v26, v26
    v_exp_f32 v27, v27
    v_exp_f32 v28, v28
    v_mfma_f32_32x32x16_bf16 v[40:55], v[12:15], v[8:11], v[56:71]
    ds_read_b128 v[12:15], v1 offset:36864
    v_exp_f32 v29, v29
    v_exp_f32 v30, v30
    v_exp_f32 v31, v31
    v_exp_f32 v32, v32
    v_exp_f32 v33, v33
    v_smfmac_f32_32x32x32_bf16 v[72:87], v[16:19], v[24:31], v3
    ds_read_b128 v[16:19], v2 offset:3072
    s_add_u32 s58, s63, 4096
    buffer_load_dwordx4 v[104:107], v7, s[24:27], s58 offen offset:0 sc1
    v_exp_f32 v34, v34
    v_exp_f32 v35, v35
    v_exp_f32 v36, v36
    v_exp_f32 v37, v37
    v_exp_f32 v38, v38
    v_exp_f32 v39, v39
    v_exp_f32 v40, v40
    v_exp_f32 v41, v41
    s_waitcnt lgkmcnt(0)
    v_smfmac_f32_32x32x32_bf16 v[72:87], v[20:23], v[32:39], v3
    ds_read_b128 v[20:23], v2 offset:3584
    v_exp_f32 v42, v42
    v_exp_f32 v43, v43
    v_exp_f32 v44, v44
    v_mfma_f32_32x32x16_bf16 v[24:39], v[12:15], v[8:11], v[56:71]
    ds_read_b128 v[12:15], v1 offset:37888
    v_exp_f32 v45, v45
    v_exp_f32 v46, v46
    v_exp_f32 v47, v47
    v_exp_f32 v48, v48
    v_exp_f32 v49, v49
    v_smfmac_f32_32x32x32_bf16 v[72:87], v[16:19], v[40:47], v3
    ds_read_b128 v[16:19], v2 offset:4096
    buffer_load_dwordx4 v[108:111], v7, s[24:27], s58 offen offset:1024 sc1
    v_exp_f32 v50, v50
    v_exp_f32 v51, v51
    v_exp_f32 v52, v52
    v_exp_f32 v53, v53
    v_exp_f32 v54, v54
    v_exp_f32 v55, v55
    v_exp_f32 v24, v24
    v_exp_f32 v25, v25
    s_waitcnt lgkmcnt(0)
    v_smfmac_f32_32x32x32_bf16 v[72:87], v[20:23], v[48:55], v3
    ds_read_b128 v[20:23], v2 offset:4608
    v_exp_f32 v26, v26
    v_exp_f32 v27, v27
    v_exp_f32 v28, v28
    v_mfma_f32_32x32x16_bf16 v[40:55], v[12:15], v[8:11], v[56:71]
    ds_read_b128 v[12:15], v1 offset:38912
    v_exp_f32 v29, v29
    v_exp_f32 v30, v30
    v_exp_f32 v31, v31
    v_exp_f32 v32, v32
    v_exp_f32 v33, v33
    v_smfmac_f32_32x32x32_bf16 v[72:87], v[16:19], v[24:31], v3
    ds_read_b128 v[16:19], v2 offset:5120
    buffer_load_dwordx4 v[112:115], v7, s[24:27], s58 offen offset:2048 sc1
    v_exp_f32 v34, v34
    v_exp_f32 v35, v35
    v_exp_f32 v36, v36
    v_exp_f32 v37, v37
    v_exp_f32 v38, v38
    v_exp_f32 v39, v39
    v_exp_f32 v40, v40
    v_exp_f32 v41, v41
    s_waitcnt lgkmcnt(0)
    v_smfmac_f32_32x32x32_bf16 v[72:87], v[20:23], v[32:39], v3
    ds_read_b128 v[20:23], v2 offset:5632
    v_exp_f32 v42, v42
    v_exp_f32 v43, v43
    v_exp_f32 v44, v44
    v_mfma_f32_32x32x16_bf16 v[24:39], v[12:15], v[8:11], v[56:71]
    ds_read_b128 v[12:15], v1 offset:39936
    v_exp_f32 v45, v45
    v_exp_f32 v46, v46
    v_exp_f32 v47, v47
    v_exp_f32 v48, v48
    v_exp_f32 v49, v49
    v_smfmac_f32_32x32x32_bf16 v[72:87], v[16:19], v[40:47], v3
    ds_read_b128 v[16:19], v2 offset:6144
    buffer_load_dwordx4 v[116:119], v7, s[24:27], s58 offen offset:3072 sc1
    v_exp_f32 v50, v50
    v_exp_f32 v51, v51
    v_exp_f32 v52, v52
    v_exp_f32 v53, v53
    v_exp_f32 v54, v54
    v_exp_f32 v55, v55
    v_exp_f32 v24, v24
    v_exp_f32 v25, v25
    s_waitcnt lgkmcnt(0)
    v_smfmac_f32_32x32x32_bf16 v[72:87], v[20:23], v[48:55], v3
    ds_read_b128 v[20:23], v2 offset:6656
    v_exp_f32 v26, v26
    v_exp_f32 v27, v27
    v_exp_f32 v28, v28
    v_mfma_f32_32x32x16_bf16 v[40:55], v[12:15], v[8:11], v[56:71]
    ds_read_b128 v[12:15], v1 offset:40960
    v_exp_f32 v29, v29
    v_exp_f32 v30, v30
    v_exp_f32 v31, v31
    v_exp_f32 v32, v32
    v_exp_f32 v33, v33
    v_smfmac_f32_32x32x32_bf16 v[72:87], v[16:19], v[24:31], v3
    ds_read_b128 v[16:19], v2 offset:7168
    s_add_u32 s58, s63, 8192
    buffer_load_dwordx4 v[120:123], v7, s[24:27], s58 offen offset:0 sc1
    v_exp_f32 v34, v34
    v_exp_f32 v35, v35
    v_exp_f32 v36, v36
    v_exp_f32 v37, v37
    v_exp_f32 v38, v38
    v_exp_f32 v39, v39
    v_exp_f32 v40, v40
    v_exp_f32 v41, v41
    s_waitcnt lgkmcnt(0)
    v_smfmac_f32_32x32x32_bf16 v[72:87], v[20:23], v[32:39], v3
    ds_read_b128 v[20:23], v2 offset:7680
    v_exp_f32 v42, v42
    v_exp_f32 v43, v43
    v_exp_f32 v44, v44
    v_mfma_f32_32x32x16_bf16 v[24:39], v[12:15], v[8:11], v[56:71]
    ds_read_b128 v[12:15], v1 offset:41984
    v_exp_f32 v45, v45
    v_exp_f32 v46, v46
    v_exp_f32 v47, v47
    v_exp_f32 v48, v48
    v_exp_f32 v49, v49
    v_smfmac_f32_32x32x32_bf16 v[72:87], v[16:19], v[40:47], v3
    ds_read_b128 v[16:19], v2 offset:8192
    buffer_load_dwordx4 v[124:127], v7, s[24:27], s58 offen offset:1024 sc1
    v_exp_f32 v50, v50
    v_exp_f32 v51, v51
    v_exp_f32 v52, v52
    v_exp_f32 v53, v53
    v_exp_f32 v54, v54
    v_exp_f32 v55, v55
    v_add_u32 v2, v4, v2
    v_exp_f32 v24, v24
    v_exp_f32 v25, v25
    s_waitcnt lgkmcnt(0)
    v_smfmac_f32_32x32x32_bf16 v[72:87], v[20:23], v[48:55], v3
    ds_read_b128 v[20:23], v2 offset:512
    v_exp_f32 v26, v26
    v_exp_f32 v27, v27
    v_exp_f32 v28, v28
    v_mfma_f32_32x32x16_bf16 v[40:55], v[12:15], v[8:11], v[56:71]
    ds_read_b128 v[12:15], v1 offset:43008
    v_exp_f32 v29, v29
    v_exp_f32 v30, v30
    v_exp_f32 v31, v31
    v_exp_f32 v32, v32
    v_exp_f32 v33, v33
    v_smfmac_f32_32x32x32_bf16 v[72:87], v[16:19], v[24:31], v3
    ds_read_b128 v[16:19], v2 offset:1024
    buffer_load_dwordx4 v[128:131], v7, s[24:27], s58 offen offset:2048 sc1
    v_exp_f32 v34, v34
    v_exp_f32 v35, v35
    v_exp_f32 v36, v36
    v_exp_f32 v37, v37
    v_exp_f32 v38, v38
    v_exp_f32 v39, v39
    v_exp_f32 v40, v40
    v_exp_f32 v41, v41
    s_waitcnt lgkmcnt(0)
    v_smfmac_f32_32x32x32_bf16 v[72:87], v[20:23], v[32:39], v3
    ds_read_b128 v[20:23], v2 offset:1536
    v_exp_f32 v42, v42
    v_exp_f32 v43, v43
    v_exp_f32 v44, v44
    v_mfma_f32_32x32x16_bf16 v[24:39], v[12:15], v[8:11], v[56:71]
    ds_read_b128 v[12:15], v1 offset:44032
    v_exp_f32 v45, v45
    v_exp_f32 v46, v46
    v_exp_f32 v47, v47
    v_exp_f32 v48, v48
    v_exp_f32 v49, v49
    v_smfmac_f32_32x32x32_bf16 v[72:87], v[16:19], v[40:47], v3
    ds_read_b128 v[16:19], v2 offset:2048
    buffer_load_dwordx4 v[132:135], v7, s[24:27], s58 offen offset:3072 sc1
    v_exp_f32 v50, v50
    v_exp_f32 v51, v51
    v_exp_f32 v52, v52
    v_exp_f32 v53, v53
    v_exp_f32 v54, v54
    v_exp_f32 v55, v55
    v_exp_f32 v24, v24
    v_exp_f32 v25, v25
    s_waitcnt lgkmcnt(0)
    v_smfmac_f32_32x32x32_bf16 v[72:87], v[20:23], v[48:55], v3
    ds_read_b128 v[20:23], v2 offset:2560
    v_exp_f32 v26, v26
    v_exp_f32 v27, v27
    v_exp_f32 v28, v28
    v_mfma_f32_32x32x16_bf16 v[40:55], v[12:15], v[8:11], v[56:71]
    ds_read_b128 v[12:15], v1 offset:45056
    v_exp_f32 v29, v29
    v_exp_f32 v30, v30
    v_exp_f32 v31, v31
    v_exp_f32 v32, v32
    v_exp_f32 v33, v33
    v_smfmac_f32_32x32x32_bf16 v[72:87], v[16:19], v[24:31], v3
    ds_read_b128 v[16:19], v2 offset:3072
    s_add_u32 s58, s63, 12288
    buffer_load_dwordx4 v[136:139], v7, s[24:27], s58 offen offset:0 sc1
    v_exp_f32 v34, v34
    v_exp_f32 v35, v35
    v_exp_f32 v36, v36
    v_exp_f32 v37, v37
    v_exp_f32 v38, v38
    v_exp_f32 v39, v39
    v_exp_f32 v40, v40
    v_exp_f32 v41, v41
    s_waitcnt lgkmcnt(0)
    v_smfmac_f32_32x32x32_bf16 v[72:87], v[20:23], v[32:39], v3
    ds_read_b128 v[20:23], v2 offset:3584
    v_exp_f32 v42, v42
    v_exp_f32 v43, v43
    v_exp_f32 v44, v44
    v_mfma_f32_32x32x16_bf16 v[24:39], v[12:15], v[8:11], v[56:71]
    ds_read_b128 v[12:15], v1 offset:46080
    v_exp_f32 v45, v45
    v_exp_f32 v46, v46
    v_exp_f32 v47, v47
    v_exp_f32 v48, v48
    v_exp_f32 v49, v49
    v_smfmac_f32_32x32x32_bf16 v[72:87], v[16:19], v[40:47], v3
    ds_read_b128 v[16:19], v2 offset:4096
    buffer_load_dwordx4 v[140:143], v7, s[24:27], s58 offen offset:1024 sc1
    v_exp_f32 v50, v50
    v_exp_f32 v51, v51
    v_exp_f32 v52, v52
    v_exp_f32 v53, v53
    v_exp_f32 v54, v54
    v_exp_f32 v55, v55
    v_exp_f32 v24, v24
    v_exp_f32 v25, v25
    s_waitcnt lgkmcnt(0)
    v_smfmac_f32_32x32x32_bf16 v[72:87], v[20:23], v[48:55], v3
    ds_read_b128 v[20:23], v2 offset:4608
    v_exp_f32 v26, v26
    v_exp_f32 v27, v27
    v_exp_f32 v28, v28
    v_mfma_f32_32x32x16_bf16 v[40:55], v[12:15], v[8:11], v[56:71]
    ds_read_b128 v[12:15], v1 offset:47104
    v_exp_f32 v29, v29
    v_exp_f32 v30, v30
    v_exp_f32 v31, v31
    v_exp_f32 v32, v32
    v_exp_f32 v33, v33
    v_smfmac_f32_32x32x32_bf16 v[72:87], v[16:19], v[24:31], v3
    ds_read_b128 v[16:19], v2 offset:5120
    buffer_load_dwordx4 v[144:147], v7, s[24:27], s58 offen offset:2048 sc1
    v_exp_f32 v34, v34
    v_exp_f32 v35, v35
    v_exp_f32 v36, v36
    v_exp_f32 v37, v37
    v_exp_f32 v38, v38
    v_exp_f32 v39, v39
    v_exp_f32 v40, v40
    v_exp_f32 v41, v41
    s_waitcnt lgkmcnt(0)
    v_smfmac_f32_32x32x32_bf16 v[72:87], v[20:23], v[32:39], v3
    ds_read_b128 v[20:23], v2 offset:5632
    v_exp_f32 v42, v42
    v_exp_f32 v43, v43
    v_exp_f32 v44, v44
    v_mfma_f32_32x32x16_bf16 v[24:39], v[12:15], v[8:11], v[56:71]
    ds_read_b128 v[12:15], v1 offset:48128
    v_exp_f32 v45, v45
    v_exp_f32 v46, v46
    v_exp_f32 v47, v47
    v_exp_f32 v48, v48
    v_exp_f32 v49, v49
    v_smfmac_f32_32x32x32_bf16 v[72:87], v[16:19], v[40:47], v3
    ds_read_b128 v[16:19], v2 offset:6144
    buffer_load_dwordx4 v[148:151], v7, s[24:27], s58 offen offset:3072 sc1
    v_exp_f32 v50, v50
    v_exp_f32 v51, v51
    v_exp_f32 v52, v52
    v_exp_f32 v53, v53
    v_exp_f32 v54, v54
    v_exp_f32 v55, v55
    v_exp_f32 v24, v24
    v_exp_f32 v25, v25
    s_waitcnt lgkmcnt(0)
    v_smfmac_f32_32x32x32_bf16 v[72:87], v[20:23], v[48:55], v3
    ds_read_b128 v[20:23], v2 offset:6656
    v_exp_f32 v26, v26
    v_exp_f32 v27, v27
    v_exp_f32 v28, v28
    v_mfma_f32_32x32x16_bf16 v[40:55], v[12:15], v[8:11], v[56:71]
    ds_read_b128 v[12:15], v1 offset:49152
    v_exp_f32 v29, v29
    v_exp_f32 v30, v30
    v_exp_f32 v31, v31
    v_exp_f32 v32, v32
    v_exp_f32 v33, v33
    v_smfmac_f32_32x32x32_bf16 v[72:87], v[16:19], v[24:31], v3
    ds_read_b128 v[16:19], v2 offset:7168
    s_add_u32 s58, s63, 16384
    buffer_load_dwordx4 v[152:155], v7, s[24:27], s58 offen offset:0 sc1
    v_exp_f32 v34, v34
    v_exp_f32 v35, v35
    v_exp_f32 v36, v36
    v_exp_f32 v37, v37
    v_exp_f32 v38, v38
    v_exp_f32 v39, v39
    v_exp_f32 v40, v40
    v_exp_f32 v41, v41
    s_waitcnt lgkmcnt(0)
    v_smfmac_f32_32x32x32_bf16 v[72:87], v[20:23], v[32:39], v3
    ds_read_b128 v[20:23], v2 offset:7680
    v_exp_f32 v42, v42
    v_exp_f32 v43, v43
    v_exp_f32 v44, v44
    v_mfma_f32_32x32x16_bf16 v[24:39], v[12:15], v[8:11], v[56:71]
    ds_read_b128 v[12:15], v1 offset:50176
    v_exp_f32 v45, v45
    v_exp_f32 v46, v46
    v_exp_f32 v47, v47
    v_exp_f32 v48, v48
    v_exp_f32 v49, v49
    v_smfmac_f32_32x32x32_bf16 v[72:87], v[16:19], v[40:47], v3
    ds_read_b128 v[16:19], v2 offset:8192
    buffer_load_dwordx4 v[156:159], v7, s[24:27], s58 offen offset:1024 sc1
    v_exp_f32 v50, v50
    v_exp_f32 v51, v51
    v_exp_f32 v52, v52
    v_exp_f32 v53, v53
    v_exp_f32 v54, v54
    v_exp_f32 v55, v55
    v_add_u32 v2, v4, v2
    v_exp_f32 v24, v24
    v_exp_f32 v25, v25
    s_waitcnt lgkmcnt(0)
    v_smfmac_f32_32x32x32_bf16 v[72:87], v[20:23], v[48:55], v3
    ds_read_b128 v[20:23], v2 offset:512
    v_exp_f32 v26, v26
    v_exp_f32 v27, v27
    v_exp_f32 v28, v28
    v_mfma_f32_32x32x16_bf16 v[40:55], v[12:15], v[8:11], v[56:71]
    ds_read_b128 v[12:15], v1 offset:51200
    s_setprio 2
    v_exp_f32 v29, v29
    v_exp_f32 v30, v30
    v_exp_f32 v31, v31
    v_exp_f32 v32, v32
    v_exp_f32 v33, v33
    v_smfmac_f32_32x32x32_bf16 v[72:87], v[16:19], v[24:31], v3
    ds_read_b128 v[16:19], v2 offset:1024
    buffer_load_dwordx4 v[160:163], v7, s[24:27], s58 offen offset:2048 sc1
    v_exp_f32 v34, v34
    v_exp_f32 v35, v35
    v_exp_f32 v36, v36
    v_exp_f32 v37, v37
    v_exp_f32 v38, v38
    v_exp_f32 v39, v39
    v_exp_f32 v40, v40
    v_exp_f32 v41, v41
    s_waitcnt lgkmcnt(0)
    v_smfmac_f32_32x32x32_bf16 v[72:87], v[20:23], v[32:39], v3
    ds_read_b128 v[20:23], v2 offset:1536
    v_exp_f32 v42, v42
    v_exp_f32 v43, v43
    v_exp_f32 v44, v44
    v_mfma_f32_32x32x16_bf16 v[24:39], v[12:15], v[8:11], v[56:71]
    ds_read_b128 v[12:15], v1 offset:52224
    v_exp_f32 v45, v45
    v_exp_f32 v46, v46
    v_exp_f32 v47, v47
    v_exp_f32 v48, v48
    v_exp_f32 v49, v49
    v_smfmac_f32_32x32x32_bf16 v[72:87], v[16:19], v[40:47], v3
    ds_read_b128 v[16:19], v2 offset:2048
    buffer_load_dwordx4 v[164:167], v7, s[24:27], s58 offen offset:3072 sc1
    v_exp_f32 v50, v50
    v_exp_f32 v51, v51
    v_exp_f32 v52, v52
    v_exp_f32 v53, v53
    v_exp_f32 v54, v54
    v_exp_f32 v55, v55
    v_exp_f32 v24, v24
    v_exp_f32 v25, v25
    s_waitcnt lgkmcnt(0)
    v_smfmac_f32_32x32x32_bf16 v[72:87], v[20:23], v[48:55], v3
    ds_read_b128 v[20:23], v2 offset:2560
    v_exp_f32 v26, v26
    v_exp_f32 v27, v27
    v_exp_f32 v28, v28
    v_mfma_f32_32x32x16_bf16 v[40:55], v[12:15], v[8:11], v[56:71]
    ds_read_b128 v[12:15], v1 offset:53248
    v_exp_f32 v29, v29
    v_exp_f32 v30, v30
    v_exp_f32 v31, v31
    v_exp_f32 v32, v32
    v_exp_f32 v33, v33
    v_smfmac_f32_32x32x32_bf16 v[72:87], v[16:19], v[24:31], v3
    ds_read_b128 v[16:19], v2 offset:3072
    s_add_u32 s58, s63, 20480
    buffer_load_dwordx4 v[168:171], v7, s[24:27], s58 offen offset:0 sc1
    buffer_load_dwordx2 v[216:217], v218, s[24:27], 0 offen sc1
    v_exp_f32 v34, v34
    v_exp_f32 v35, v35
    v_exp_f32 v36, v36
    v_exp_f32 v37, v37
    v_exp_f32 v38, v38
    v_exp_f32 v39, v39
    v_exp_f32 v40, v40
    v_exp_f32 v41, v41
    s_waitcnt lgkmcnt(0)
    v_smfmac_f32_32x32x32_bf16 v[72:87], v[20:23], v[32:39], v3
    ds_read_b128 v[20:23], v2 offset:3584
    v_exp_f32 v42, v42
    v_exp_f32 v43, v43
    v_exp_f32 v44, v44
    v_mfma_f32_32x32x16_bf16 v[24:39], v[12:15], v[8:11], v[56:71]
    ds_read_b128 v[12:15], v1 offset:54272
    v_exp_f32 v45, v45
    v_exp_f32 v46, v46
    v_exp_f32 v47, v47
    v_exp_f32 v48, v48
    v_exp_f32 v49, v49
    v_smfmac_f32_32x32x32_bf16 v[72:87], v[16:19], v[40:47], v3
    ds_read_b128 v[16:19], v2 offset:4096
    buffer_load_dwordx4 v[172:175], v7, s[24:27], s58 offen offset:1024 sc1
    v_exp_f32 v50, v50
    v_exp_f32 v51, v51
    v_exp_f32 v52, v52
    v_exp_f32 v53, v53
    v_exp_f32 v54, v54
    v_exp_f32 v55, v55
    v_exp_f32 v24, v24
    v_exp_f32 v25, v25
    s_waitcnt lgkmcnt(0)
    v_smfmac_f32_32x32x32_bf16 v[72:87], v[20:23], v[48:55], v3
    ds_read_b128 v[20:23], v2 offset:4608
    v_exp_f32 v26, v26
    v_exp_f32 v27, v27
    v_exp_f32 v28, v28
    v_mfma_f32_32x32x16_bf16 v[40:55], v[12:15], v[8:11], v[56:71]
    ds_read_b128 v[12:15], v1 offset:55296
    v_exp_f32 v29, v29
    v_exp_f32 v30, v30
    v_exp_f32 v31, v31
    v_exp_f32 v32, v32
    v_exp_f32 v33, v33
    v_smfmac_f32_32x32x32_bf16 v[72:87], v[16:19], v[24:31], v3
    ds_read_b128 v[16:19], v2 offset:5120
    buffer_load_dwordx4 v[176:179], v7, s[24:27], s58 offen offset:2048 sc1
    v_exp_f32 v34, v34
    v_exp_f32 v35, v35
    v_exp_f32 v36, v36
    v_exp_f32 v37, v37
    v_exp_f32 v38, v38
    v_exp_f32 v39, v39
    v_exp_f32 v40, v40
    v_exp_f32 v41, v41
    s_waitcnt lgkmcnt(0)
    v_smfmac_f32_32x32x32_bf16 v[72:87], v[20:23], v[32:39], v3
    ds_read_b128 v[20:23], v2 offset:5632
    v_exp_f32 v42, v42
    v_exp_f32 v43, v43
    v_exp_f32 v44, v44
    v_mfma_f32_32x32x16_bf16 v[24:39], v[12:15], v[8:11], v[56:71]
    ds_read_b128 v[12:15], v1 offset:56320
    v_exp_f32 v45, v45
    v_exp_f32 v46, v46
    v_exp_f32 v47, v47
    v_exp_f32 v48, v48
    v_exp_f32 v49, v49
    v_smfmac_f32_32x32x32_bf16 v[72:87], v[16:19], v[40:47], v3
    ds_read_b128 v[16:19], v2 offset:6144
    buffer_load_dwordx4 v[180:183], v7, s[24:27], s58 offen offset:3072 sc1
    v_exp_f32 v50, v50
    v_exp_f32 v51, v51
    v_exp_f32 v52, v52
    v_exp_f32 v53, v53
    v_exp_f32 v54, v54
    v_exp_f32 v55, v55
    v_exp_f32 v24, v24
    v_exp_f32 v25, v25
    s_waitcnt lgkmcnt(0)
    v_smfmac_f32_32x32x32_bf16 v[72:87], v[20:23], v[48:55], v3
    ds_read_b128 v[20:23], v2 offset:6656
    v_exp_f32 v26, v26
    v_exp_f32 v27, v27
    v_exp_f32 v28, v28
    v_mfma_f32_32x32x16_bf16 v[40:55], v[12:15], v[8:11], v[56:71]
    ds_read_b128 v[12:15], v1 offset:57344
    v_exp_f32 v29, v29
    v_exp_f32 v30, v30
    v_exp_f32 v31, v31
    v_exp_f32 v32, v32
    v_exp_f32 v33, v33
    v_smfmac_f32_32x32x32_bf16 v[72:87], v[16:19], v[24:31], v3
    ds_read_b128 v[16:19], v2 offset:7168
    s_add_u32 s58, s63, 24576
    buffer_load_dwordx4 v[184:187], v7, s[24:27], s58 offen offset:0 sc1
    v_exp_f32 v34, v34
    v_exp_f32 v35, v35
    v_exp_f32 v36, v36
    v_exp_f32 v37, v37
    v_exp_f32 v38, v38
    v_exp_f32 v39, v39
    v_exp_f32 v40, v40
    v_exp_f32 v41, v41
    s_waitcnt lgkmcnt(0)
    v_smfmac_f32_32x32x32_bf16 v[72:87], v[20:23], v[32:39], v3
    ds_read_b128 v[20:23], v2 offset:7680
    v_exp_f32 v42, v42
    v_exp_f32 v43, v43
    v_exp_f32 v44, v44
    v_mfma_f32_32x32x16_bf16 v[24:39], v[12:15], v[8:11], v[56:71]
    ds_read_b128 v[12:15], v1 offset:58368
    v_exp_f32 v45, v45
    v_exp_f32 v46, v46
    v_exp_f32 v47, v47
    v_exp_f32 v48, v48
    v_exp_f32 v49, v49
    v_smfmac_f32_32x32x32_bf16 v[72:87], v[16:19], v[40:47], v3
    ds_read_b128 v[16:19], v2 offset:8192
    buffer_load_dwordx4 v[188:191], v7, s[24:27], s58 offen offset:1024 sc1
    v_exp_f32 v50, v50
    v_exp_f32 v51, v51
    v_exp_f32 v52, v52
    v_exp_f32 v53, v53
    v_exp_f32 v54, v54
    v_exp_f32 v55, v55
    v_add_u32 v2, v4, v2
    v_exp_f32 v24, v24
    v_exp_f32 v25, v25
    s_waitcnt lgkmcnt(0)
    v_smfmac_f32_32x32x32_bf16 v[72:87], v[20:23], v[48:55], v3
    ds_read_b128 v[20:23], v2 offset:512
    v_exp_f32 v26, v26
    v_exp_f32 v27, v27
    v_exp_f32 v28, v28
    v_mfma_f32_32x32x16_bf16 v[40:55], v[12:15], v[8:11], v[56:71]
    ds_read_b128 v[12:15], v1 offset:59392
    s_setprio 1
    v_exp_f32 v29, v29
    v_exp_f32 v30, v30
    v_exp_f32 v31, v31
    v_exp_f32 v32, v32
    v_exp_f32 v33, v33
    v_smfmac_f32_32x32x32_bf16 v[72:87], v[16:19], v[24:31], v3
    ds_read_b128 v[16:19], v2 offset:1024
    buffer_load_dwordx4 v[192:195], v7, s[24:27], s58 offen offset:2048 sc1
    v_exp_f32 v34, v34
    v_exp_f32 v35, v35
    v_exp_f32 v36, v36
    v_exp_f32 v37, v37
    v_exp_f32 v38, v38
    v_exp_f32 v39, v39
    v_exp_f32 v40, v40
    v_exp_f32 v41, v41
    s_waitcnt lgkmcnt(0)
    v_smfmac_f32_32x32x32_bf16 v[72:87], v[20:23], v[32:39], v3
    ds_read_b128 v[20:23], v2 offset:1536
    v_exp_f32 v42, v42
    v_exp_f32 v43, v43
    v_exp_f32 v44, v44
    v_mfma_f32_32x32x16_bf16 v[24:39], v[12:15], v[8:11], v[56:71]
    ds_read_b128 v[12:15], v1 offset:60416
    v_exp_f32 v45, v45
    v_exp_f32 v46, v46
    v_exp_f32 v47, v47
    v_exp_f32 v48, v48
    v_exp_f32 v49, v49
    v_smfmac_f32_32x32x32_bf16 v[72:87], v[16:19], v[40:47], v3
    ds_read_b128 v[16:19], v2 offset:2048
    buffer_load_dwordx4 v[196:199], v7, s[24:27], s58 offen offset:3072 sc1
    v_exp_f32 v50, v50
    v_exp_f32 v51, v51
    v_exp_f32 v52, v52
    v_exp_f32 v53, v53
    v_exp_f32 v54, v54
    v_exp_f32 v55, v55
    v_exp_f32 v24, v24
    v_exp_f32 v25, v25
    s_waitcnt lgkmcnt(0)
    v_smfmac_f32_32x32x32_bf16 v[72:87], v[20:23], v[48:55], v3
    ds_read_b128 v[20:23], v2 offset:2560
    v_exp_f32 v26, v26
    v_exp_f32 v27, v27
    v_exp_f32 v28, v28
    v_mfma_f32_32x32x16_bf16 v[40:55], v[12:15], v[8:11], v[56:71]
    ds_read_b128 v[12:15], v1 offset:61440
    v_exp_f32 v29, v29
    v_exp_f32 v30, v30
    v_exp_f32 v31, v31
    v_exp_f32 v32, v32
    v_exp_f32 v33, v33
    v_smfmac_f32_32x32x32_bf16 v[72:87], v[16:19], v[24:31], v3
    ds_read_b128 v[16:19], v2 offset:3072
    v_exp_f32 v34, v34
    v_exp_f32 v35, v35
    v_exp_f32 v36, v36
    v_exp_f32 v37, v37
    v_exp_f32 v38, v38
    v_exp_f32 v39, v39
    v_exp_f32 v40, v40
    v_exp_f32 v41, v41
    s_waitcnt lgkmcnt(0)
    v_smfmac_f32_32x32x32_bf16 v[72:87], v[20:23], v[32:39], v3
    ds_read_b128 v[20:23], v2 offset:3584
    v_exp_f32 v42, v42
    v_exp_f32 v43, v43
    v_exp_f32 v44, v44
    v_mfma_f32_32x32x16_bf16 v[24:39], v[12:15], v[8:11], v[56:71]
    ds_read_b128 v[12:15], v1 offset:62464
    v_exp_f32 v45, v45
    v_exp_f32 v46, v46
    v_exp_f32 v47, v47
    v_exp_f32 v48, v48
    v_exp_f32 v49, v49
    v_smfmac_f32_32x32x32_bf16 v[72:87], v[16:19], v[40:47], v3
    ds_read_b128 v[16:19], v2 offset:4096
    v_exp_f32 v50, v50
    v_exp_f32 v51, v51
    v_exp_f32 v52, v52
    v_exp_f32 v53, v53
    v_exp_f32 v54, v54
    v_exp_f32 v55, v55
    v_exp_f32 v24, v24
    v_exp_f32 v25, v25
    s_waitcnt lgkmcnt(0)
    v_smfmac_f32_32x32x32_bf16 v[72:87], v[20:23], v[48:55], v3
    ds_read_b128 v[20:23], v2 offset:4608
    v_exp_f32 v26, v26
    v_exp_f32 v27, v27
    v_exp_f32 v28, v28
    v_mfma_f32_32x32x16_bf16 v[40:55], v[12:15], v[8:11], v[56:71]
    ds_read_b128 v[12:15], v1 offset:63488
    v_exp_f32 v29, v29
    v_exp_f32 v30, v30
    v_exp_f32 v31, v31
    v_exp_f32 v32, v32
    v_exp_f32 v33, v33
    v_smfmac_f32_32x32x32_bf16 v[72:87], v[16:19], v[24:31], v3
    ds_read_b128 v[16:19], v2 offset:5120
    v_exp_f32 v34, v34
    v_exp_f32 v35, v35
    v_exp_f32 v36, v36
    v_exp_f32 v37, v37
    v_exp_f32 v38, v38
    v_exp_f32 v39, v39
    v_exp_f32 v40, v40
    v_exp_f32 v41, v41
    s_waitcnt lgkmcnt(0)
    v_smfmac_f32_32x32x32_bf16 v[72:87], v[20:23], v[32:39], v3
    ds_read_b128 v[20:23], v2 offset:5632
    v_exp_f32 v42, v42
    v_exp_f32 v43, v43
    v_exp_f32 v44, v44
    v_mfma_f32_32x32x16_bf16 v[24:39], v[12:15], v[8:11], v[56:71]
    ds_read_b128 v[12:15], v1 offset:64512
    s_setprio 0
    v_exp_f32 v45, v45
    v_exp_f32 v46, v46
    v_exp_f32 v47, v47
    v_exp_f32 v48, v48
    v_exp_f32 v49, v49
    v_smfmac_f32_32x32x32_bf16 v[72:87], v[16:19], v[40:47], v3
    ds_read_b128 v[16:19], v2 offset:6144
    v_exp_f32 v50, v50
    v_exp_f32 v51, v51
    v_exp_f32 v52, v52
    v_exp_f32 v53, v53
    v_exp_f32 v54, v54
    v_exp_f32 v55, v55
    v_exp_f32 v24, v24
    v_exp_f32 v25, v25
    s_waitcnt lgkmcnt(0)
    v_smfmac_f32_32x32x32_bf16 v[72:87], v[20:23], v[48:55], v3
    ds_read_b128 v[20:23], v2 offset:6656
    v_exp_f32 v26, v26
    v_exp_f32 v27, v27
    v_exp_f32 v28, v28
    v_mfma_f32_32x32x16_bf16 v[40:55], v[12:15], v[8:11], v[56:71]
    v_exp_f32 v29, v29
    v_exp_f32 v30, v30
    v_exp_f32 v31, v31
    v_exp_f32 v32, v32
    v_exp_f32 v33, v33
    v_smfmac_f32_32x32x32_bf16 v[72:87], v[16:19], v[24:31], v3
    ds_read_b128 v[16:19], v2 offset:7168
    v_exp_f32 v34, v34
    v_exp_f32 v35, v35
    v_exp_f32 v36, v36
    v_exp_f32 v37, v37
    v_exp_f32 v38, v38
    v_exp_f32 v39, v39
    v_exp_f32 v40, v40
    v_exp_f32 v41, v41
    s_waitcnt lgkmcnt(0)
    v_smfmac_f32_32x32x32_bf16 v[72:87], v[20:23], v[32:39], v3
    ds_read_b128 v[20:23], v2 offset:7680
    v_exp_f32 v42, v42
    v_exp_f32 v43, v43
    v_exp_f32 v44, v44
    v_exp_f32 v45, v45
    v_exp_f32 v46, v46
    v_exp_f32 v47, v47
    v_exp_f32 v48, v48
    v_exp_f32 v49, v49
    v_smfmac_f32_32x32x32_bf16 v[72:87], v[16:19], v[40:47], v3
    buffer_load_dwordx2 v[216:217], v218, s[24:27], 0 offen sc1
    v_exp_f32 v50, v50
    v_exp_f32 v51, v51
    v_exp_f32 v52, v52
    v_exp_f32 v53, v53
    v_exp_f32 v54, v54
    v_exp_f32 v55, v55
    s_branch F_attn_done
.p2align 6
F_roleB:
    v_exp_f32 v24, v24
    v_exp_f32 v25, v25
    s_waitcnt lgkmcnt(0)
    ds_read_b128 v[20:23], v2 offset:512
    v_exp_f32 v26, v26
    v_exp_f32 v27, v27
    v_exp_f32 v28, v28
    v_mfma_f32_32x32x16_bf16 v[40:55], v[12:15], v[8:11], v[56:71]
    ds_read_b128 v[12:15], v1 offset:2048
    s_setprio 3
    v_exp_f32 v29, v29
    v_exp_f32 v30, v30
    v_exp_f32 v31, v31
    v_exp_f32 v32, v32
    v_exp_f32 v33, v33
    v_smfmac_f32_32x32x32_bf16 v[72:87], v[16:19], v[24:31], v3
    ds_read_b128 v[16:19], v2 offset:1024
    v_exp_f32 v34, v34
    v_exp_f32 v35, v35
    v_exp_f32 v36, v36
    v_exp_f32 v37, v37
    v_exp_f32 v38, v38
    v_exp_f32 v39, v39
    v_exp_f32 v40, v40
    v_exp_f32 v41, v41
    s_waitcnt lgkmcnt(0)
    v_smfmac_f32_32x32x32_bf16 v[72:87], v[20:23], v[32:39], v3
    ds_read_b128 v[20:23], v2 offset:1536
    v_exp_f32 v42, v42
    v_exp_f32 v43, v43
    v_exp_f32 v44, v44
    v_mfma_f32_32x32x16_bf16 v[24:39], v[12:15], v[8:11], v[56:71]
    ds_read_b128 v[12:15], v1 offset:3072
    v_exp_f32 v45, v45
    v_exp_f32 v46, v46
    v_exp_f32 v47, v47
    v_exp_f32 v48, v48
    v_exp_f32 v49, v49
    v_smfmac_f32_32x32x32_bf16 v[72:87], v[16:19], v[40:47], v3
    ds_read_b128 v[16:19], v2 offset:2048
    v_exp_f32 v50, v50
    v_exp_f32 v51, v51
    v_exp_f32 v52, v52
    v_exp_f32 v53, v53
    v_exp_f32 v54, v54
    v_exp_f32 v55, v55
    v_exp_f32 v24, v24
    v_exp_f32 v25, v25
    s_waitcnt lgkmcnt(0)
    v_smfmac_f32_32x32x32_bf16 v[72:87], v[20:23], v[48:55], v3
    ds_read_b128 v[20:23], v2 offset:2560
    v_exp_f32 v26, v26
    v_exp_f32 v27, v27
    v_exp_f32 v28, v28
    v_mfma_f32_32x32x16_bf16 v[40:55], v[12:15], v[8:11], v[56:71]
    ds_read_b128 v[12:15], v1 offset:4096
    v_exp_f32 v29, v29
    v_exp_f32 v30, v30
    v_exp_f32 v31, v31
    v_exp_f32 v32, v32
    v_exp_f32 v33, v33
    v_smfmac_f32_32x32x32_bf16 v[72:87], v[16:19], v[24:31], v3
    ds_read_b128 v[16:19], v2 offset:3072
    s_mov_b64 exec, s[70:71]
    buffer_store_dwordx4 v[192:195], v7, s[24:27], s47 offen sc1
    s_mov_b64 exec, -1
    v_exp_f32 v34, v34
    v_exp_f32 v35, v35
    v_exp_f32 v36, v36
    v_exp_f32 v37, v37
    v_exp_f32 v38, v38
    v_exp_f32 v39, v39
    v_exp_f32 v40, v40
    v_exp_f32 v41, v41
    s_waitcnt lgkmcnt(0)
    v_smfmac_f32_32x32x32_bf16 v[72:87], v[20:23], v[32:39], v3
    ds_read_b128 v[20:23], v2 offset:3584
    v_exp_f32 v42, v42
    v_exp_f32 v43, v43
    v_exp_f32 v44, v44
    v_mfma_f32_32x32x16_bf16 v[24:39], v[12:15], v[8:11], v[56:71]
    ds_read_b128 v[12:15], v1 offset:5120
    v_exp_f32 v45, v45
    v_exp_f32 v46, v46
    v_exp_f32 v47, v47
    v_exp_f32 v48, v48
    v_exp_f32 v49, v49
    v_smfmac_f32_32x32x32_bf16 v[72:87], v[16:19], v[40:47], v3
    ds_read_b128 v[16:19], v2 offset:4096
    v_exp_f32 v50, v50
    v_exp_f32 v51, v51
    v_exp_f32 v52, v52
    v_exp_f32 v53, v53
    v_exp_f32 v54, v54
    v_exp_f32 v55, v55
    v_exp_f32 v24, v24
    v_exp_f32 v25, v25
    s_waitcnt lgkmcnt(0)
    v_smfmac_f32_32x32x32_bf16 v[72:87], v[20:23], v[48:55], v3
    ds_read_b128 v[20:23], v2 offset:4608
    v_exp_f32 v26, v26
    v_exp_f32 v27, v27
    v_exp_f32 v28, v28
    v_mfma_f32_32x32x16_bf16 v[40:55], v[12:15], v[8:11], v[56:71]
    ds_read_b128 v[12:15], v1 offset:6144
    v_exp_f32 v29, v29
    v_exp_f32 v30, v30
    v_exp_f32 v31, v31
    v_exp_f32 v32, v32
    v_exp_f32 v33, v33
    v_smfmac_f32_32x32x32_bf16 v[72:87], v[16:19], v[24:31], v3
    ds_read_b128 v[16:19], v2 offset:5120
    v_exp_f32 v34, v34
    v_exp_f32 v35, v35
    v_exp_f32 v36, v36
    v_exp_f32 v37, v37
    v_exp_f32 v38, v38
    v_exp_f32 v39, v39
    v_exp_f32 v40, v40
    v_exp_f32 v41, v41
    s_waitcnt lgkmcnt(0)
    v_smfmac_f32_32x32x32_bf16 v[72:87], v[20:23], v[32:39], v3
    ds_read_b128 v[20:23], v2 offset:5632
    v_exp_f32 v42, v42
    v_exp_f32 v43, v43
    v_exp_f32 v44, v44
    v_mfma_f32_32x32x16_bf16 v[24:39], v[12:15], v[8:11], v[56:71]
    ds_read_b128 v[12:15], v1 offset:7168
    v_exp_f32 v45, v45
    v_exp_f32 v46, v46
    v_exp_f32 v47, v47
    v_exp_f32 v48, v48
    v_exp_f32 v49, v49
    v_smfmac_f32_32x32x32_bf16 v[72:87], v[16:19], v[40:47], v3
    ds_read_b128 v[16:19], v2 offset:6144
    v_exp_f32 v50, v50
    v_exp_f32 v51, v51
    v_exp_f32 v52, v52
    v_exp_f32 v53, v53
    v_exp_f32 v54, v54
    v_exp_f32 v55, v55
    v_exp_f32 v24, v24
    v_exp_f32 v25, v25
    s_waitcnt lgkmcnt(0)
    v_smfmac_f32_32x32x32_bf16 v[72:87], v[20:23], v[48:55], v3
    ds_read_b128 v[20:23], v2 offset:6656
    buffer_load_dwordx2 v[188:189], v190, s[24:27], 0 offen sc1
    v_exp_f32 v26, v26
    v_exp_f32 v27, v27
    v_exp_f32 v28, v28
    v_mfma_f32_32x32x16_bf16 v[40:55], v[12:15], v[8:11], v[56:71]
    ds_read_b128 v[12:15], v1 offset:8192
    v_exp_f32 v29, v29
    v_exp_f32 v30, v30
    v_exp_f32 v31, v31
    v_exp_f32 v32, v32
    v_exp_f32 v33, v33
    v_smfmac_f32_32x32x32_bf16 v[72:87], v[16:19], v[24:31], v3
    ds_read_b128 v[16:19], v2 offset:7168
    v_exp_f32 v34, v34
    v_exp_f32 v35, v35
    v_exp_f32 v36, v36
    v_exp_f32 v37, v37
    v_exp_f32 v38, v38
    v_exp_f32 v39, v39
    v_exp_f32 v40, v40
    v_exp_f32 v41, v41
    s_waitcnt lgkmcnt(0)
    v_smfmac_f32_32x32x32_bf16 v[72:87], v[20:23], v[32:39], v3
    ds_read_b128 v[20:23], v2 offset:7680
    v_exp_f32 v42, v42
    v_exp_f32 v43, v43
    v_exp_f32 v44, v44
    v_mfma_f32_32x32x16_bf16 v[24:39], v[12:15], v[8:11], v[56:71]
    ds_read_b128 v[12:15], v1 offset:9216
    v_exp_f32 v45, v45
    v_exp_f32 v46, v46
    v_exp_f32 v47, v47
    v_exp_f32 v48, v48
    v_exp_f32 v49, v49
    v_smfmac_f32_32x32x32_bf16 v[72:87], v[16:19], v[40:47], v3
    ds_read_b128 v[16:19], v2 offset:8192
    v_exp_f32 v50, v50
    v_exp_f32 v51, v51
    v_exp_f32 v52, v52
    v_exp_f32 v53, v53
    v_exp_f32 v54, v54
    v_exp_f32 v55, v55
    v_add_u32 v2, v4, v2
    v_exp_f32 v24, v24
    v_exp_f32 v25, v25
    s_waitcnt lgkmcnt(0)
    v_smfmac_f32_32x32x32_bf16 v[72:87], v[20:23], v[48:55], v3
    ds_read_b128 v[20:23], v2 offset:512
    v_exp_f32 v26, v26
    v_exp_f32 v27, v27
    v_exp_f32 v28, v28
    v_mfma_f32_32x32x16_bf16 v[40:55], v[12:15], v[8:11], v[56:71]
    ds_read_b128 v[12:15], v1 offset:10240
    s_setprio 2
    v_exp_f32 v29, v29
    v_exp_f32 v30, v30
    v_exp_f32 v31, v31
    v_exp_f32 v32, v32
    v_exp_f32 v33, v33
    v_smfmac_f32_32x32x32_bf16 v[72:87], v[16:19], v[24:31], v3
    ds_read_b128 v[16:19], v2 offset:1024
    v_exp_f32 v34, v34
    v_exp_f32 v35, v35
    v_exp_f32 v36, v36
    v_exp_f32 v37, v37
    v_exp_f32 v38, v38
    v_exp_f32 v39, v39
    s_waitcnt vmcnt(0)
    v_cmp_ne_u64 vcc, s[48:49], v[188:189]
    s_nop 0
    s_and_b64 vcc, vcc, 16711680
    s_cbranch_vccz F_c2_ok
    s_mov_b32 s62, 0
F_c2_spin:
    buffer_load_dwordx2 v[188:189], v190, s[24:27], 0 offen sc1
    s_waitcnt vmcnt(0)
    v_cmp_ne_u64 vcc, s[48:49], v[188:189]
    s_add_u32 s62, s62, 1
    s_and_b64 vcc, vcc, 16711680
    s_cbranch_vccz F_c2_ok
    s_cmp_lt_u32 s62, 262144
    s_cbranch_scc1 F_c2_spin
F_c2_ok:
    v_exp_f32 v40, v40
    v_exp_f32 v41, v41
    s_waitcnt lgkmcnt(0)
    v_smfmac_f32_32x32x32_bf16 v[72:87], v[20:23], v[32:39], v3
    ds_read_b128 v[20:23], v2 offset:1536
    s_add_u32 m0, s57, 16384
    s_add_u32 s67, s55, 2621440
    buffer_load_dwordx4 v7, s[24:27], s67 offen offset:0 sc1 lds
    buffer_load_dwordx4 v7, s[24:27], s67 offen offset:1024 sc1 lds
    v_exp_f32 v42, v42
    v_exp_f32 v43, v43
    v_exp_f32 v44, v44
    v_mfma_f32_32x32x16_bf16 v[24:39], v[12:15], v[8:11], v[56:71]
    ds_read_b128 v[12:15], v1 offset:11264
    v_exp_f32 v45, v45
    v_exp_f32 v46, v46
    v_exp_f32 v47, v47
    v_exp_f32 v48, v48
    v_exp_f32 v49, v49
    v_smfmac_f32_32x32x32_bf16 v[72:87], v[16:19], v[40:47], v3
    ds_read_b128 v[16:19], v2 offset:2048
    s_add_u32 m0, s57, 81920
    s_add_u32 s67, s55, 4718592
    buffer_load_dwordx4 v7, s[24:27], s67 offen offset:0 sc1 lds
    buffer_load_dwordx4 v7, s[24:27], s67 offen offset:1024 sc1 lds
    v_exp_f32 v50, v50
    v_exp_f32 v51, v51
    v_exp_f32 v52, v52
    v_exp_f32 v53, v53
    v_exp_f32 v54, v54
    v_exp_f32 v55, v55
    v_exp_f32 v24, v24
    v_exp_f32 v25, v25
    s_waitcnt lgkmcnt(0)
    v_smfmac_f32_32x32x32_bf16 v[72:87], v[20:23], v[48:55], v3
    ds_read_b128 v[20:23], v2 offset:2560
    s_add_u32 m0, s57, 24576
    s_add_u32 s67, s55, 2883584
    buffer_load_dwordx4 v7, s[24:27], s67 offen offset:0 sc1 lds
    buffer_load_dwordx4 v7, s[24:27], s67 offen offset:1024 sc1 lds
    v_exp_f32 v26, v26
    v_exp_f32 v27, v27
    v_exp_f32 v28, v28
    v_mfma_f32_32x32x16_bf16 v[40:55], v[12:15], v[8:11], v[56:71]
    ds_read_b128 v[12:15], v1 offset:12288
    v_exp_f32 v29, v29
    v_exp_f32 v30, v30
    v_exp_f32 v31, v31
    v_exp_f32 v32, v32
    v_exp_f32 v33, v33
    v_smfmac_f32_32x32x32_bf16 v[72:87], v[16:19], v[24:31], v3
    ds_read_b128 v[16:19], v2 offset:3072
    s_add_u32 m0, s57, 90112
    s_add_u32 s67, s55, 4980736
    buffer_load_dwordx4 v7, s[24:27], s67 offen offset:0 sc1 lds
    buffer_load_dwordx4 v7, s[24:27], s67 offen offset:1024 sc1 lds
    v_exp_f32 v34, v34
    v_exp_f32 v35, v35
    v_exp_f32 v36, v36
    v_exp_f32 v37, v37
    v_exp_f32 v38, v38
    v_exp_f32 v39, v39
    v_exp_f32 v40, v40
    v_exp_f32 v41, v41
    s_waitcnt lgkmcnt(0)
    v_smfmac_f32_32x32x32_bf16 v[72:87], v[20:23], v[32:39], v3
    ds_read_b128 v[20:23], v2 offset:3584
    v_exp_f32 v42, v42
    v_exp_f32 v43, v43
    v_exp_f32 v44, v44
    v_mfma_f32_32x32x16_bf16 v[24:39], v[12:15], v[8:11], v[56:71]
    ds_read_b128 v[12:15], v1 offset:13312
    v_exp_f32 v45, v45
    v_exp_f32 v46, v46
    v_exp_f32 v47, v47
    v_exp_f32 v48, v48
    v_exp_f32 v49, v49
    v_smfmac_f32_32x32x32_bf16 v[72:87], v[16:19], v[40:47], v3
    ds_read_b128 v[16:19], v2 offset:4096
    v_exp_f32 v50, v50
    v_exp_f32 v51, v51
    v_exp_f32 v52, v52
    v_exp_f32 v53, v53
    v_exp_f32 v54, v54
    v_exp_f32 v55, v55
    v_exp_f32 v24, v24
    v_exp_f32 v25, v25
    s_waitcnt lgkmcnt(0)
    v_smfmac_f32_32x32x32_bf16 v[72:87], v[20:23], v[48:55], v3
    ds_read_b128 v[20:23], v2 offset:4608
    v_exp_f32 v26, v26
    v_exp_f32 v27, v27
    v_exp_f32 v28, v28
    v_mfma_f32_32x32x16_bf16 v[40:55], v[12:15], v[8:11], v[56:71]
    ds_read_b128 v[12:15], v1 offset:14336
    s_setprio 1
    v_exp_f32 v29, v29
    v_exp_f32 v30, v30
    v_exp_f32 v31, v31
    v_exp_f32 v32, v32
    v_exp_f32 v33, v33
    v_smfmac_f32_32x32x32_bf16 v[72:87], v[16:19], v[24:31], v3
    ds_read_b128 v[16:19], v2 offset:5120
    v_exp_f32 v34, v34
    v_exp_f32 v35, v35
    v_exp_f32 v36, v36
    v_exp_f32 v37, v37
    v_exp_f32 v38, v38
    v_exp_f32 v39, v39
    v_exp_f32 v40, v40
    v_exp_f32 v41, v41
    s_waitcnt lgkmcnt(0)
    v_smfmac_f32_32x32x32_bf16 v[72:87], v[20:23], v[32:39], v3
    ds_read_b128 v[20:23], v2 offset:5632
    v_exp_f32 v42, v42
    v_exp_f32 v43, v43
    v_exp_f32 v44, v44
    v_mfma_f32_32x32x16_bf16 v[24:39], v[12:15], v[8:11], v[56:71]
    ds_read_b128 v[12:15], v1 offset:15360
    v_exp_f32 v45, v45
    v_exp_f32 v46, v46
    v_exp_f32 v47, v47
    v_exp_f32 v48, v48
    v_exp_f32 v49, v49
    v_smfmac_f32_32x32x32_bf16 v[72:87], v[16:19], v[40:47], v3
    ds_read_b128 v[16:19], v2 offset:6144
    v_exp_f32 v50, v50
    v_exp_f32 v51, v51
    v_exp_f32 v52, v52
    v_exp_f32 v53, v53
    v_exp_f32 v54, v54
    v_exp_f32 v55, v55
    s_waitcnt vmcnt(0)
    s_barrier
    v_exp_f32 v24, v24
    v_exp_f32 v25, v25
    s_waitcnt lgkmcnt(0)
    v_smfmac_f32_32x32x32_bf16 v[72:87], v[20:23], v[48:55], v3
    ds_read_b128 v[20:23], v2 offset:6656
    buffer_load_dwordx2 v[188:189], v190, s[24:27], 0 offen sc1
    v_exp_f32 v26, v26
    v_exp_f32 v27, v27
    v_exp_f32 v28, v28
    v_mfma_f32_32x32x16_bf16 v[40:55], v[12:15], v[8:11], v[56:71]
    ds_read_b128 v[12:15], v1 offset:16384
    s_setprio 3
    v_exp_f32 v29, v29
    v_exp_f32 v30, v30
    v_exp_f32 v31, v31
    v_exp_f32 v32, v32
    v_exp_f32 v33, v33
    v_smfmac_f32_32x32x32_bf16 v[72:87], v[16:19], v[24:31], v3
    ds_read_b128 v[16:19], v2 offset:7168
    v_exp_f32 v34, v34
    v_exp_f32 v35, v35
    v_exp_f32 v36, v36
    v_exp_f32 v37, v37
    v_exp_f32 v38, v38
    v_exp_f32 v39, v39
    v_exp_f32 v40, v40
    v_exp_f32 v41, v41
    s_waitcnt lgkmcnt(0)
    v_smfmac_f32_32x32x32_bf16 v[72:87], v[20:23], v[32:39], v3
    ds_read_b128 v[20:23], v2 offset:7680
    v_exp_f32 v42, v42
    v_exp_f32 v43, v43
    v_exp_f32 v44, v44
    v_mfma_f32_32x32x16_bf16 v[24:39], v[12:15], v[8:11], v[56:71]
    ds_read_b128 v[12:15], v1 offset:17408
    v_exp_f32 v45, v45
    v_exp_f32 v46, v46
    v_exp_f32 v47, v47
    v_exp_f32 v48, v48
    v_exp_f32 v49, v49
    v_smfmac_f32_32x32x32_bf16 v[72:87], v[16:19], v[40:47], v3
    ds_read_b128 v[16:19], v2 offset:8192
    v_exp_f32 v50, v50
    v_exp_f32 v51, v51
    v_exp_f32 v52, v52
    v_exp_f32 v53, v53
    v_exp_f32 v54, v54
    v_exp_f32 v55, v55
    v_add_u32 v2, v4, v2
    v_exp_f32 v24, v24
    v_exp_f32 v25, v25
    s_waitcnt lgkmcnt(0)
    v_smfmac_f32_32x32x32_bf16 v[72:87], v[20:23], v[48:55], v3
    ds_read_b128 v[20:23], v2 offset:512
    v_exp_f32 v26, v26
    v_exp_f32 v27, v27
    v_exp_f32 v28, v28
    v_mfma_f32_32x32x16_bf16 v[40:55], v[12:15], v[8:11], v[56:71]
    ds_read_b128 v[12:15], v1 offset:18432
    v_exp_f32 v29, v29
    v_exp_f32 v30, v30
    v_exp_f32 v31, v31
    v_exp_f32 v32, v32
    v_exp_f32 v33, v33
    v_smfmac_f32_32x32x32_bf16 v[72:87], v[16:19], v[24:31], v3
    ds_read_b128 v[16:19], v2 offset:1024
    v_exp_f32 v34, v34
    v_exp_f32 v35, v35
    v_exp_f32 v36, v36
    v_exp_f32 v37, v37
    v_exp_f32 v38, v38
    v_exp_f32 v39, v39
    v_exp_f32 v40, v40
    v_exp_f32 v41, v41
    s_waitcnt lgkmcnt(0)
    v_smfmac_f32_32x32x32_bf16 v[72:87], v[20:23], v[32:39], v3
    ds_read_b128 v[20:23], v2 offset:1536
    v_exp_f32 v42, v42
    v_exp_f32 v43, v43
    v_exp_f32 v44, v44
    v_mfma_f32_32x32x16_bf16 v[24:39], v[12:15], v[8:11], v[56:71]
    ds_read_b128 v[12:15], v1 offset:19456
    v_exp_f32 v45, v45
    v_exp_f32 v46, v46
    v_exp_f32 v47, v47
    v_exp_f32 v48, v48
    v_exp_f32 v49, v49
    v_smfmac_f32_32x32x32_bf16 v[72:87], v[16:19], v[40:47], v3
    ds_read_b128 v[16:19], v2 offset:2048
    v_exp_f32 v50, v50
    v_exp_f32 v51, v51
    v_exp_f32 v52, v52
    v_exp_f32 v53, v53
    v_exp_f32 v54, v54
    v_exp_f32 v55, v55
    s_waitcnt vmcnt(0)
    v_cmp_ne_u64 vcc, s[48:49], v[188:189]
    s_nop 0
    s_cbranch_vccz F_c4_ok
    s_mov_b32 s62, 0
F_c4_spin:
    buffer_load_dwordx2 v[188:189], v190, s[24:27], 0 offen sc1
    s_waitcnt vmcnt(0)
    v_cmp_ne_u64 vcc, s[48:49], v[188:189]
    s_add_u32 s62, s62, 1
    s_cbranch_vccz F_c4_ok
    s_cmp_lt_u32 s62, 262144
    s_cbranch_scc1 F_c4_spin
F_c4_ok:
    v_exp_f32 v24, v24
    v_exp_f32 v25, v25
    s_waitcnt lgkmcnt(0)
    v_smfmac_f32_32x32x32_bf16 v[72:87], v[20:23], v[48:55], v3
    ds_read_b128 v[20:23], v2 offset:2560
    s_add_u32 m0, s57, 32768
    s_add_u32 s67, s55, 3145728
    buffer_load_dwordx4 v7, s[24:27], s67 offen offset:0 sc1 lds
    v_exp_f32 v26, v26
    v_exp_f32 v27, v27
    v_exp_f32 v28, v28
    v_mfma_f32_32x32x16_bf16 v[40:55], v[12:15], v[8:11], v[56:71]
    ds_read_b128 v[12:15], v1 offset:20480
    v_exp_f32 v29, v29
    v_exp_f32 v30, v30
    v_exp_f32 v31, v31
    v_exp_f32 v32, v32
    v_exp_f32 v33, v33
    v_smfmac_f32_32x32x32_bf16 v[72:87], v[16:19], v[24:31], v3
    ds_read_b128 v[16:19], v2 offset:3072
    buffer_load_dwordx4 v7, s[24:27], s67 offen offset:1024 sc1 lds
    v_exp_f32 v34, v34
    v_exp_f32 v35, v35
    v_exp_f32 v36, v36
    v_exp_f32 v37, v37
    v_exp_f32 v38, v38
    v_exp_f32 v39, v39
    v_exp_f32 v40, v40
    v_exp_f32 v41, v41
    s_waitcnt lgkmcnt(0)
    v_smfmac_f32_32x32x32_bf16 v[72:87], v[20:23], v[32:39], v3
    ds_read_b128 v[20:23], v2 offset:3584
    s_add_u32 m0, s57, 98304
    s_add_u32 s67, s55, 5242880
    buffer_load_dwordx4 v7, s[24:27], s67 offen offset:0 sc1 lds
    v_exp_f32 v42, v42
    v_exp_f32 v43, v43
    v_exp_f32 v44, v44
    v_mfma_f32_32x32x16_bf16 v[24:39], v[12:15], v[8:11], v[56:71]
    ds_read_b128 v[12:15], v1 offset:21504
    v_exp_f32 v45, v45
    v_exp_f32 v46, v46
    v_exp_f32 v47, v47
    v_exp_f32 v48, v48
    v_exp_f32 v49, v49
    v_smfmac_f32_32x32x32_bf16 v[72:87], v[16:19], v[40:47], v3
    ds_read_b128 v[16:19], v2 offset:4096
    buffer_load_dwordx4 v7, s[24:27], s67 offen offset:1024 sc1 lds
    buffer_store_dwordx4 v[220:223], v7, s[24:27], s72 offen sc1
    v_exp_f32 v50, v50
    v_exp_f32 v51, v51
    v_exp_f32 v52, v52
    v_exp_f32 v53, v53
    v_exp_f32 v54, v54
    v_exp_f32 v55, v55
    v_exp_f32 v24, v24
    v_exp_f32 v25, v25
    s_waitcnt lgkmcnt(0)
    v_smfmac_f32_32x32x32_bf16 v[72:87], v[20:23], v[48:55], v3
    ds_read_b128 v[20:23], v2 offset:4608
    s_add_u32 m0, s57, 40960
    s_add_u32 s67, s55, 3407872
    buffer_load_dwordx4 v7, s[24:27], s67 offen offset:0 sc1 lds
    v_exp_f32 v26, v26
    v_exp_f32 v27, v27
    v_exp_f32 v28, v28
    v_mfma_f32_32x32x16_bf16 v[40:55], v[12:15], v[8:11], v[56:71]
    ds_read_b128 v[12:15], v1 offset:22528
    v_exp_f32 v29, v29
    v_exp_f32 v30, v30
    v_exp_f32 v31, v31
    v_exp_f32 v32, v32
    v_exp_f32 v33, v33
    v_smfmac_f32_32x32x32_bf16 v[72:87], v[16:19], v[24:31], v3
    ds_read_b128 v[16:19], v2 offset:5120
    buffer_load_dwordx4 v7, s[24:27], s67 offen offset:1024 sc1 lds
    v_exp_f32 v34, v34
    v_exp_f32 v35, v35
    v_exp_f32 v36, v36
    v_exp_f32 v37, v37
    v_exp_f32 v38, v38
    v_exp_f32 v39, v39
    v_exp_f32 v40, v40
    v_exp_f32 v41, v41
    s_waitcnt lgkmcnt(0)
    v_smfmac_f32_32x32x32_bf16 v[72:87], v[20:23], v[32:39], v3
    ds_read_b128 v[20:23], v2 offset:5632
    s_add_u32 m0, s57, 106496
    s_add_u32 s67, s55, 5505024
    buffer_load_dwordx4 v7, s[24:27], s67 offen offset:0 sc1 lds
    v_exp_f32 v42, v42
    v_exp_f32 v43, v43
    v_exp_f32 v44, v44
    v_mfma_f32_32x32x16_bf16 v[24:39], v[12:15], v[8:11], v[56:71]
    ds_read_b128 v[12:15], v1 offset:23552
    v_exp_f32 v45, v45
    v_exp_f32 v46, v46
    v_exp_f32 v47, v47
    v_exp_f32 v48, v48
    v_exp_f32 v49, v49
    v_smfmac_f32_32x32x32_bf16 v[72:87], v[16:19], v[40:47], v3
    ds_read_b128 v[16:19], v2 offset:6144
    buffer_load_dwordx4 v7, s[24:27], s67 offen offset:1024 sc1 lds
    v_exp_f32 v50, v50
    v_exp_f32 v51, v51
    v_exp_f32 v52, v52
    v_exp_f32 v53, v53
    v_exp_f32 v54, v54
    v_exp_f32 v55, v55
    v_exp_f32 v24, v24
    v_exp_f32 v25, v25
    s_waitcnt lgkmcnt(0)
    v_smfmac_f32_32x32x32_bf16 v[72:87], v[20:23], v[48:55], v3
    ds_read_b128 v[20:23], v2 offset:6656
    s_add_u32 m0, s57, 49152
    s_add_u32 s67, s55, 3670016
    buffer_load_dwordx4 v7, s[24:27], s67 offen offset:0 sc1 lds
    v_exp_f32 v26, v26
    v_exp_f32 v27, v27
    v_exp_f32 v28, v28
    v_mfma_f32_32x32x16_bf16 v[40:55], v[12:15], v[8:11], v[56:71]
    ds_read_b128 v[12:15], v1 offset:24576
    v_exp_f32 v29, v29
    v_exp_f32 v30, v30
    v_exp_f32 v31, v31
    v_exp_f32 v32, v32
    v_exp_f32 v33, v33
    v_smfmac_f32_32x32x32_bf16 v[72:87], v[16:19], v[24:31], v3
    ds_read_b128 v[16:19], v2 offset:7168
    buffer_load_dwordx4 v7, s[24:27], s67 offen offset:1024 sc1 lds
    v_exp_f32 v34, v34
    v_exp_f32 v35, v35
    v_exp_f32 v36, v36
    v_exp_f32 v37, v37
    v_exp_f32 v38, v38
    v_exp_f32 v39, v39
    v_exp_f32 v40, v40
    v_exp_f32 v41, v41
    s_waitcnt lgkmcnt(0)
    v_smfmac_f32_32x32x32_bf16 v[72:87], v[20:23], v[32:39], v3
    ds_read_b128 v[20:23], v2 offset:7680
    s_add_u32 m0, s57, 114688
    s_add_u32 s67, s55, 5767168
    buffer_load_dwordx4 v7, s[24:27], s67 offen offset:0 sc1 lds
    v_exp_f32 v42, v42
    v_exp_f32 v43, v43
    v_exp_f32 v44, v44
    v_mfma_f32_32x32x16_bf16 v[24:39], v[12:15], v[8:11], v[56:71]
    ds_read_b128 v[12:15], v1 offset:25600
    s_setprio 2
    v_exp_f32 v45, v45
    v_exp_f32 v46, v46
    v_exp_f32 v47, v47
    v_exp_f32 v48, v48
    v_exp_f32 v49, v49
    v_smfmac_f32_32x32x32_bf16 v[72:87], v[16:19], v[40:47], v3
    ds_read_b128 v[16:19], v2 offset:8192
    buffer_load_dwordx4 v7, s[24:27], s67 offen offset:1024 sc1 lds
    v_exp_f32 v50, v50
    v_exp_f32 v51, v51
    v_exp_f32 v52, v52
    v_exp_f32 v53, v53
    v_exp_f32 v54, v54
    v_exp_f32 v55, v55
    v_add_u32 v2, v4, v2
    v_exp_f32 v24, v24
    v_exp_f32 v25, v25
    s_waitcnt lgkmcnt(0)
    v_smfmac_f32_32x32x32_bf16 v[72:87], v[20:23], v[48:55], v3
    ds_read_b128 v[20:23], v2 offset:512
    s_add_u32 m0, s57, 57344
    s_add_u32 s67, s55, 3932160
    buffer_load_dwordx4 v7, s[24:27], s67 offen offset:0 sc1 lds
    v_exp_f32 v26, v26
    v_exp_f32 v27, v27
    v_exp_f32 v28, v28
    v_mfma_f32_32x32x16_bf16 v[40:55], v[12:15], v[8:11], v[56:71]
    ds_read_b128 v[12:15], v1 offset:26624
    v_exp_f32 v29, v29
    v_exp_f32 v30, v30
    v_exp_f32 v31, v31
    v_exp_f32 v32, v32
    v_exp_f32 v33, v33
    v_smfmac_f32_32x32x32_bf16 v[72:87], v[16:19], v[24:31], v3
    ds_read_b128 v[16:19], v2 offset:1024
    buffer_load_dwordx4 v7, s[24:27], s67 offen offset:1024 sc1 lds
    v_exp_f32 v34, v34
    v_exp_f32 v35, v35
    v_exp_f32 v36, v36
    v_exp_f32 v37, v37
    v_exp_f32 v38, v38
    v_exp_f32 v39, v39
    v_exp_f32 v40, v40
    v_exp_f32 v41, v41
    s_waitcnt lgkmcnt(0)
    v_smfmac_f32_32x32x32_bf16 v[72:87], v[20:23], v[32:39], v3
    ds_read_b128 v[20:23], v2 offset:1536
    s_add_u32 m0, s57, 122880
    s_add_u32 s67, s55, 6029312
    buffer_load_dwordx4 v7, s[24:27], s67 offen offset:0 sc1 lds
    v_exp_f32 v42, v42
    v_exp_f32 v43, v43
    v_exp_f32 v44, v44
    v_mfma_f32_32x32x16_bf16 v[24:39], v[12:15], v[8:11], v[56:71]
    ds_read_b128 v[12:15], v1 offset:27648
    v_exp_f32 v45, v45
    v_exp_f32 v46, v46
    v_exp_f32 v47, v47
    v_exp_f32 v48, v48
    v_exp_f32 v49, v49
    v_smfmac_f32_32x32x32_bf16 v[72:87], v[16:19], v[40:47], v3
    ds_read_b128 v[16:19], v2 offset:2048
    buffer_load_dwordx4 v7, s[24:27], s67 offen offset:1024 sc1 lds
    v_exp_f32 v50, v50
    v_exp_f32 v51, v51
    v_exp_f32 v52, v52
    v_exp_f32 v53, v53
    v_exp_f32 v54, v54
    v_exp_f32 v55, v55
    v_exp_f32 v24, v24
    v_exp_f32 v25, v25
    s_waitcnt lgkmcnt(0)
    v_smfmac_f32_32x32x32_bf16 v[72:87], v[20:23], v[48:55], v3
    ds_read_b128 v[20:23], v2 offset:2560
    buffer_load_dwordx2 v[188:189], v187, s[24:27], 0 offen sc1
    v_exp_f32 v26, v26
    v_exp_f32 v27, v27
    v_exp_f32 v28, v28
    v_mfma_f32_32x32x16_bf16 v[40:55], v[12:15], v[8:11], v[56:71]
    ds_read_b128 v[12:15], v1 offset:28672
    v_exp_f32 v29, v29
    v_exp_f32 v30, v30
    v_exp_f32 v31, v31
    v_exp_f32 v32, v32
    v_exp_f32 v33, v33
    v_smfmac_f32_32x32x32_bf16 v[72:87], v[16:19], v[24:31], v3
    ds_read_b128 v[16:19], v2 offset:3072
    v_exp_f32 v34, v34
    v_exp_f32 v35, v35
    v_exp_f32 v36, v36
    v_exp_f32 v37, v37
    v_exp_f32 v38, v38
    v_exp_f32 v39, v39
    v_exp_f32 v40, v40
    v_exp_f32 v41, v41
    s_waitcnt lgkmcnt(0)
    v_smfmac_f32_32x32x32_bf16 v[72:87], v[20:23], v[32:39], v3
    ds_read_b128 v[20:23], v2 offset:3584
    v_exp_f32 v42, v42
    v_exp_f32 v43, v43
    v_exp_f32 v44, v44
    v_mfma_f32_32x32x16_bf16 v[24:39], v[12:15], v[8:11], v[56:71]
    ds_read_b128 v[12:15], v1 offset:29696
    s_setprio 1
    v_exp_f32 v45, v45
    v_exp_f32 v46, v46
    v_exp_f32 v47, v47
    v_exp_f32 v48, v48
    v_exp_f32 v49, v49
    v_smfmac_f32_32x32x32_bf16 v[72:87], v[16:19], v[40:47], v3
    ds_read_b128 v[16:19], v2 offset:4096
    v_exp_f32 v50, v50
    v_exp_f32 v51, v51
    v_exp_f32 v52, v52
    v_exp_f32 v53, v53
    v_exp_f32 v54, v54
    v_exp_f32 v55, v55
    v_exp_f32 v24, v24
    v_exp_f32 v25, v25
    s_waitcnt lgkmcnt(0)
    v_smfmac_f32_32x32x32_bf16 v[72:87], v[20:23], v[48:55], v3
    ds_read_b128 v[20:23], v2 offset:4608
    v_exp_f32 v26, v26
    v_exp_f32 v27, v27
    v_exp_f32 v28, v28
    v_mfma_f32_32x32x16_bf16 v[40:55], v[12:15], v[8:11], v[56:71]
    ds_read_b128 v[12:15], v1 offset:30720
    v_exp_f32 v29, v29
    v_exp_f32 v30, v30
    v_exp_f32 v31, v31
    v_exp_f32 v32, v32
    v_exp_f32 v33, v33
    v_smfmac_f32_32x32x32_bf16 v[72:87], v[16:19], v[24:31], v3
    ds_read_b128 v[16:19], v2 offset:5120
    v_exp_f32 v34, v34
    v_exp_f32 v35, v35
    v_exp_f32 v36, v36
    v_exp_f32 v37, v37
    v_exp_f32 v38, v38
    v_exp_f32 v39, v39
    v_exp_f32 v40, v40
    v_exp_f32 v41, v41
    s_waitcnt lgkmcnt(0)
    v_smfmac_f32_32x32x32_bf16 v[72:87], v[20:23], v[32:39], v3
    ds_read_b128 v[20:23], v2 offset:5632
    v_exp_f32 v42, v42
    v_exp_f32 v43, v43
    v_exp_f32 v44, v44
    v_mfma_f32_32x32x16_bf16 v[24:39], v[12:15], v[8:11], v[56:71]
    ds_read_b128 v[12:15], v1 offset:31744
    v_exp_f32 v45, v45
    v_exp_f32 v46, v46
    v_exp_f32 v47, v47
    v_exp_f32 v48, v48
    v_exp_f32 v49, v49
    v_smfmac_f32_32x32x32_bf16 v[72:87], v[16:19], v[40:47], v3
    ds_read_b128 v[16:19], v2 offset:6144
    v_exp_f32 v50, v50
    v_exp_f32 v51, v51
    v_exp_f32 v52, v52
    v_exp_f32 v53, v53
    v_exp_f32 v54, v54
    v_exp_f32 v55, v55
    s_waitcnt vmcnt(0)
    v_cmp_ne_u64 vcc, s[48:49], v[188:189]
    s_nop 0
    s_cbranch_vccz F_all_ok
    s_mov_b32 s62, 0
F_all_spin:
    buffer_load_dwordx2 v[188:189], v187, s[24:27], 0 offen sc1
    s_waitcnt vmcnt(0)
    v_cmp_ne_u64 vcc, s[48:49], v[188:189]
    s_add_u32 s62, s62, 1
    s_cbranch_vccz F_all_ok
    s_cmp_lt_u32 s62, 262144
    s_cbranch_scc1 F_all_spin
F_all_ok:
    s_barrier
    v_exp_f32 v24, v24
    v_exp_f32 v25, v25
    s_waitcnt lgkmcnt(0)
    v_smfmac_f32_32x32x32_bf16 v[72:87], v[20:23], v[48:55], v3
    ds_read_b128 v[20:23], v2 offset:6656
    v_exp_f32 v26, v26
    v_exp_f32 v27, v27
    v_exp_f32 v28, v28
    v_mfma_f32_32x32x16_bf16 v[40:55], v[12:15], v[8:11], v[56:71]
    ds_read_b128 v[12:15], v1 offset:32768
    s_setprio 3
    v_exp_f32 v29, v29
    v_exp_f32 v30, v30
    v_exp_f32 v31, v31
    v_exp_f32 v32, v32
    v_exp_f32 v33, v33
    v_smfmac_f32_32x32x32_bf16 v[72:87], v[16:19], v[24:31], v3
    ds_read_b128 v[16:19], v2 offset:7168
    v_exp_f32 v34, v34
    v_exp_f32 v35, v35
    v_exp_f32 v36, v36
    v_exp_f32 v37, v37
    v_exp_f32 v38, v38
    v_exp_f32 v39, v39
    v_exp_f32 v40, v40
    v_exp_f32 v41, v41
    s_waitcnt lgkmcnt(0)
    v_smfmac_f32_32x32x32_bf16 v[72:87], v[20:23], v[32:39], v3
    ds_read_b128 v[20:23], v2 offset:7680
    v_exp_f32 v42, v42
    v_exp_f32 v43, v43
    v_exp_f32 v44, v44
    v_mfma_f32_32x32x16_bf16 v[24:39], v[12:15], v[8:11], v[56:71]
    ds_read_b128 v[12:15], v1 offset:33792
    v_exp_f32 v45, v45
    v_exp_f32 v46, v46
    v_exp_f32 v47, v47
    v_exp_f32 v48, v48
    v_exp_f32 v49, v49
    v_smfmac_f32_32x32x32_bf16 v[72:87], v[16:19], v[40:47], v3
    ds_read_b128 v[16:19], v2 offset:8192
    v_mov_b32 v220, s48
    v_mov_b32 v221, s49
    v_exp_f32 v50, v50
    v_exp_f32 v51, v51
    v_exp_f32 v52, v52
    v_exp_f32 v53, v53
    v_exp_f32 v54, v54
    v_exp_f32 v55, v55
    v_add_u32 v2, v4, v2
    v_exp_f32 v24, v24
    v_exp_f32 v25, v25
    s_waitcnt lgkmcnt(0)
    v_smfmac_f32_32x32x32_bf16 v[72:87], v[20:23], v[48:55], v3
    ds_read_b128 v[20:23], v2 offset:512
    v_exp_f32 v26, v26
    v_exp_f32 v27, v27
    v_exp_f32 v28, v28
    v_mfma_f32_32x32x16_bf16 v[40:55], v[12:15], v[8:11], v[56:71]
    ds_read_b128 v[12:15], v1 offset:34816
    v_exp_f32 v29, v29
    v_exp_f32 v30, v30
    v_exp_f32 v31, v31
    v_exp_f32 v32, v32
    v_exp_f32 v33, v33
    v_smfmac_f32_32x32x32_bf16 v[72:87], v[16:19], v[24:31], v3
    ds_read_b128 v[16:19], v2 offset:1024
    s_add_u32 s58, s63, 0
    buffer_load_dwordx4 v[120:123], v184, s[24:27], s58 offen sc1
    v_exp_f32 v34, v34
    v_exp_f32 v35, v35
    v_exp_f32 v36, v36
    v_exp_f32 v37, v37
    v_exp_f32 v38, v38
    v_exp_f32 v39, v39
    v_exp_f32 v40, v40
    v_exp_f32 v41, v41
    s_waitcnt lgkmcnt(0)
    v_smfmac_f32_32x32x32_bf16 v[72:87], v[20:23], v[32:39], v3
    ds_read_b128 v[20:23], v2 offset:1536
    v_exp_f32 v42, v42
    v_exp_f32 v43, v43
    v_exp_f32 v44, v44
    v_mfma_f32_32x32x16_bf16 v[24:39], v[12:15], v[8:11], v[56:71]
    ds_read_b128 v[12:15], v1 offset:35840
    v_exp_f32 v45, v45
    v_exp_f32 v46, v46
    v_exp_f32 v47, v47
    v_exp_f32 v48, v48
    v_exp_f32 v49, v49
    v_smfmac_f32_32x32x32_bf16 v[72:87], v[16:19], v[40:47], v3
    ds_read_b128 v[16:19], v2 offset:2048
    buffer_load_dwordx4 v[124:127], v186, s[24:27], s58 offen sc1
    v_exp_f32 v50, v50
    v_exp_f32 v51, v51
    v_exp_f32 v52, v52
    v_exp_f32 v53, v53
    v_exp_f32 v54, v54
    v_exp_f32 v55, v55
    v_exp_f32 v24, v24
    v_exp_f32 v25, v25
    s_waitcnt lgkmcnt(0)
    v_smfmac_f32_32x32x32_bf16 v[72:87], v[20:23], v[48:55], v3
    ds_read_b128 v[20:23], v2 offset:2560
    v_exp_f32 v26, v26
    v_exp_f32 v27, v27
    v_exp_f32 v28, v28
    v_mfma_f32_32x32x16_bf16 v[40:55], v[12:15], v[8:11], v[56:71]
    ds_read_b128 v[12:15], v1 offset:36864
    v_exp_f32 v29, v29
    v_exp_f32 v30, v30
    v_exp_f32 v31, v31
    v_exp_f32 v32, v32
    v_exp_f32 v33, v33
    v_smfmac_f32_32x32x32_bf16 v[72:87], v[16:19], v[24:31], v3
    ds_read_b128 v[16:19], v2 offset:3072
    s_add_u32 s58, s63, 1114112
    buffer_load_dwordx4 v[128:131], v185, s[24:27], s58 offen sc1
    v_exp_f32 v34, v34
    v_exp_f32 v35, v35
    v_exp_f32 v36, v36
    v_exp_f32 v37, v37
    v_exp_f32 v38, v38
    v_exp_f32 v39, v39
    v_exp_f32 v40, v40
    v_exp_f32 v41, v41
    s_waitcnt lgkmcnt(0)
    v_smfmac_f32_32x32x32_bf16 v[72:87], v[20:23], v[32:39], v3
    ds_read_b128 v[20:23], v2 offset:3584
    v_exp_f32 v42, v42
    v_exp_f32 v43, v43
    v_exp_f32 v44, v44
    v_mfma_f32_32x32x16_bf16 v[24:39], v[12:15], v[8:11], v[56:71]
    ds_read_b128 v[12:15], v1 offset:37888
    v_exp_f32 v45, v45
    v_exp_f32 v46, v46
    v_exp_f32 v47, v47
    v_exp_f32 v48, v48
    v_exp_f32 v49, v49
    v_smfmac_f32_32x32x32_bf16 v[72:87], v[16:19], v[40:47], v3
    ds_read_b128 v[16:19], v2 offset:4096
    buffer_load_dwordx4 v[132:135], v186, s[24:27], s58 offen sc1
    v_exp_f32 v50, v50
    v_exp_f32 v51, v51
    v_exp_f32 v52, v52
    v_exp_f32 v53, v53
    v_exp_f32 v54, v54
    v_exp_f32 v55, v55
    v_exp_f32 v24, v24
    v_exp_f32 v25, v25
    s_waitcnt lgkmcnt(0)
    v_smfmac_f32_32x32x32_bf16 v[72:87], v[20:23], v[48:55], v3
    ds_read_b128 v[20:23], v2 offset:4608
    v_exp_f32 v26, v26
    v_exp_f32 v27, v27
    v_exp_f32 v28, v28
    v_mfma_f32_32x32x16_bf16 v[40:55], v[12:15], v[8:11], v[56:71]
    ds_read_b128 v[12:15], v1 offset:38912
    v_exp_f32 v29, v29
    v_exp_f32 v30, v30
    v_exp_f32 v31, v31
    v_exp_f32 v32, v32
    v_exp_f32 v33, v33
    v_smfmac_f32_32x32x32_bf16 v[72:87], v[16:19], v[24:31], v3
    ds_read_b128 v[16:19], v2 offset:5120
    s_add_u32 s58, s63, 8704
    buffer_load_dwordx4 v[136:139], v184, s[24:27], s58 offen sc1
    v_exp_f32 v34, v34
    v_exp_f32 v35, v35
    v_exp_f32 v36, v36
    v_exp_f32 v37, v37
    v_exp_f32 v38, v38
    v_exp_f32 v39, v39
    v_exp_f32 v40, v40
    v_exp_f32 v41, v41
    s_waitcnt lgkmcnt(0)
    v_smfmac_f32_32x32x32_bf16 v[72:87], v[20:23], v[32:39], v3
    ds_read_b128 v[20:23], v2 offset:5632
    v_exp_f32 v42, v42
    v_exp_f32 v43, v43
    v_exp_f32 v44, v44
    v_mfma_f32_32x32x16_bf16 v[24:39], v[12:15], v[8:11], v[56:71]
    ds_read_b128 v[12:15], v1 offset:39936
    v_exp_f32 v45, v45
    v_exp_f32 v46, v46
    v_exp_f32 v47, v47
    v_exp_f32 v48, v48
    v_exp_f32 v49, v49
    v_smfmac_f32_32x32x32_bf16 v[72:87], v[16:19], v[40:47], v3
    ds_read_b128 v[16:19], v2 offset:6144
    buffer_load_dwordx4 v[140:143], v186, s[24:27], s58 offen sc1
    v_exp_f32 v50, v50
    v_exp_f32 v51, v51
    v_exp_f32 v52, v52
    v_exp_f32 v53, v53
    v_exp_f32 v54, v54
    v_exp_f32 v55, v55
    v_exp_f32 v24, v24
    v_exp_f32 v25, v25
    s_waitcnt lgkmcnt(0)
    v_smfmac_f32_32x32x32_bf16 v[72:87], v[20:23], v[48:55], v3
    ds_read_b128 v[20:23], v2 offset:6656
    v_exp_f32 v26, v26
    v_exp_f32 v27, v27
    v_exp_f32 v28, v28
    v_mfma_f32_32x32x16_bf16 v[40:55], v[12:15], v[8:11], v[56:71]
    ds_read_b128 v[12:15], v1 offset:40960
    v_exp_f32 v29, v29
    v_exp_f32 v30, v30
    v_exp_f32 v31, v31
    v_exp_f32 v32, v32
    v_exp_f32 v33, v33
    v_smfmac_f32_32x32x32_bf16 v[72:87], v[16:19], v[24:31], v3
    ds_read_b128 v[16:19], v2 offset:7168
    s_add_u32 s58, s63, 1122816
    buffer_load_dwordx4 v[144:147], v185, s[24:27], s58 offen sc1
    v_exp_f32 v34, v34
    v_exp_f32 v35, v35
    v_exp_f32 v36, v36
    v_exp_f32 v37, v37
    v_exp_f32 v38, v38
    v_exp_f32 v39, v39
    v_exp_f32 v40, v40
    v_exp_f32 v41, v41
    s_waitcnt lgkmcnt(0)
    v_smfmac_f32_32x32x32_bf16 v[72:87], v[20:23], v[32:39], v3
    ds_read_b128 v[20:23], v2 offset:7680
    v_exp_f32 v42, v42
    v_exp_f32 v43, v43
    v_exp_f32 v44, v44
    v_mfma_f32_32x32x16_bf16 v[24:39], v[12:15], v[8:11], v[56:71]
    ds_read_b128 v[12:15], v1 offset:41984
    v_exp_f32 v45, v45
    v_exp_f32 v46, v46
    v_exp_f32 v47, v47
    v_exp_f32 v48, v48
    v_exp_f32 v49, v49
    v_smfmac_f32_32x32x32_bf16 v[72:87], v[16:19], v[40:47], v3
    ds_read_b128 v[16:19], v2 offset:8192
    buffer_load_dwordx4 v[148:151], v186, s[24:27], s58 offen sc1
    v_exp_f32 v50, v50
    v_exp_f32 v51, v51
    v_exp_f32 v52, v52
    v_exp_f32 v53, v53
    v_exp_f32 v54, v54
    v_exp_f32 v55, v55
    v_add_u32 v2, v4, v2
    v_exp_f32 v24, v24
    v_exp_f32 v25, v25
    s_waitcnt lgkmcnt(0)
    v_smfmac_f32_32x32x32_bf16 v[72:87], v[20:23], v[48:55], v3
    ds_read_b128 v[20:23], v2 offset:512
    v_exp_f32 v26, v26
    v_exp_f32 v27, v27
    v_exp_f32 v28, v28
    v_mfma_f32_32x32x16_bf16 v[40:55], v[12:15], v[8:11], v[56:71]
    ds_read_b128 v[12:15], v1 offset:43008
    v_exp_f32 v29, v29
    v_exp_f32 v30, v30
    v_exp_f32 v31, v31
    v_exp_f32 v32, v32
    v_exp_f32 v33, v33
    v_smfmac_f32_32x32x32_bf16 v[72:87], v[16:19], v[24:31], v3
    ds_read_b128 v[16:19], v2 offset:1024
    s_add_u32 s58, s63, 17408
    buffer_load_dwordx4 v[152:155], v184, s[24:27], s58 offen sc1
    v_exp_f32 v34, v34
    v_exp_f32 v35, v35
    v_exp_f32 v36, v36
    v_exp_f32 v37, v37
    v_exp_f32 v38, v38
    v_exp_f32 v39, v39
    v_exp_f32 v40, v40
    v_exp_f32 v41, v41
    s_waitcnt lgkmcnt(0)
    v_smfmac_f32_32x32x32_bf16 v[72:87], v[20:23], v[32:39], v3
    ds_read_b128 v[20:23], v2 offset:1536
    v_exp_f32 v42, v42
    v_exp_f32 v43, v43
    v_exp_f32 v44, v44
    v_mfma_f32_32x32x16_bf16 v[24:39], v[12:15], v[8:11], v[56:71]
    ds_read_b128 v[12:15], v1 offset:44032
    v_exp_f32 v45, v45
    v_exp_f32 v46, v46
    v_exp_f32 v47, v47
    v_exp_f32 v48, v48
    v_exp_f32 v49, v49
    v_smfmac_f32_32x32x32_bf16 v[72:87], v[16:19], v[40:47], v3
    ds_read_b128 v[16:19], v2 offset:2048
    buffer_load_dwordx4 v[156:159], v186, s[24:27], s58 offen sc1
    v_exp_f32 v50, v50
    v_exp_f32 v51, v51
    v_exp_f32 v52, v52
    v_exp_f32 v53, v53
    v_exp_f32 v54, v54
    v_exp_f32 v55, v55
    v_exp_f32 v24, v24
    v_exp_f32 v25, v25
    s_waitcnt lgkmcnt(0)
    v_smfmac_f32_32x32x32_bf16 v[72:87], v[20:23], v[48:55], v3
    ds_read_b128 v[20:23], v2 offset:2560
    v_exp_f32 v26, v26
    v_exp_f32 v27, v27
    v_exp_f32 v28, v28
    v_mfma_f32_32x32x16_bf16 v[40:55], v[12:15], v[8:11], v[56:71]
    ds_read_b128 v[12:15], v1 offset:45056
    v_exp_f32 v29, v29
    v_exp_f32 v30, v30
    v_exp_f32 v31, v31
    v_exp_f32 v32, v32
    v_exp_f32 v33, v33
    v_smfmac_f32_32x32x32_bf16 v[72:87], v[16:19], v[24:31], v3
    ds_read_b128 v[16:19], v2 offset:3072
    s_add_u32 s58, s63, 1131520
    buffer_load_dwordx4 v[160:163], v185, s[24:27], s58 offen sc1
    v_exp_f32 v34, v34
    v_exp_f32 v35, v35
    v_exp_f32 v36, v36
    v_exp_f32 v37, v37
    v_exp_f32 v38, v38
    v_exp_f32 v39, v39
    v_exp_f32 v40, v40
    v_exp_f32 v41, v41
    s_waitcnt lgkmcnt(0)
    v_smfmac_f32_32x32x32_bf16 v[72:87], v[20:23], v[32:39], v3
    ds_read_b128 v[20:23], v2 offset:3584
    v_exp_f32 v42, v42
    v_exp_f32 v43, v43
    v_exp_f32 v44, v44
    v_mfma_f32_32x32x16_bf16 v[24:39], v[12:15], v[8:11], v[56:71]
    ds_read_b128 v[12:15], v1 offset:46080
    v_exp_f32 v45, v45
    v_exp_f32 v46, v46
    v_exp_f32 v47, v47
    v_exp_f32 v48, v48
    v_exp_f32 v49, v49
    v_smfmac_f32_32x32x32_bf16 v[72:87], v[16:19], v[40:47], v3
    ds_read_b128 v[16:19], v2 offset:4096
    buffer_load_dwordx4 v[164:167], v186, s[24:27], s58 offen sc1
    v_exp_f32 v50, v50
    v_exp_f32 v51, v51
    v_exp_f32 v52, v52
    v_exp_f32 v53, v53
    v_exp_f32 v54, v54
    v_exp_f32 v55, v55
    v_exp_f32 v24, v24
    v_exp_f32 v25, v25
    s_waitcnt lgkmcnt(0)
    v_smfmac_f32_32x32x32_bf16 v[72:87], v[20:23], v[48:55], v3
    ds_read_b128 v[20:23], v2 offset:4608
    v_exp_f32 v26, v26
    v_exp_f32 v27, v27
    v_exp_f32 v28, v28
    v_mfma_f32_32x32x16_bf16 v[40:55], v[12:15], v[8:11], v[56:71]
    ds_read_b128 v[12:15], v1 offset:47104
    v_exp_f32 v29, v29
    v_exp_f32 v30, v30
    v_exp_f32 v31, v31
    v_exp_f32 v32, v32
    v_exp_f32 v33, v33
    v_smfmac_f32_32x32x32_bf16 v[72:87], v[16:19], v[24:31], v3
    ds_read_b128 v[16:19], v2 offset:5120
    s_add_u32 s58, s63, 26112
    buffer_load_dwordx4 v[168:171], v184, s[24:27], s58 offen sc1
    v_exp_f32 v34, v34
    v_exp_f32 v35, v35
    v_exp_f32 v36, v36
    v_exp_f32 v37, v37
    v_exp_f32 v38, v38
    v_exp_f32 v39, v39
    v_exp_f32 v40, v40
    v_exp_f32 v41, v41
    s_waitcnt lgkmcnt(0)
    v_smfmac_f32_32x32x32_bf16 v[72:87], v[20:23], v[32:39], v3
    ds_read_b128 v[20:23], v2 offset:5632
    v_exp_f32 v42, v42
    v_exp_f32 v43, v43
    v_exp_f32 v44, v44
    v_mfma_f32_32x32x16_bf16 v[24:39], v[12:15], v[8:11], v[56:71]
    ds_read_b128 v[12:15], v1 offset:48128
    v_exp_f32 v45, v45
    v_exp_f32 v46, v46
    v_exp_f32 v47, v47
    v_exp_f32 v48, v48
    v_exp_f32 v49, v49
    v_smfmac_f32_32x32x32_bf16 v[72:87], v[16:19], v[40:47], v3
    ds_read_b128 v[16:19], v2 offset:6144
    buffer_load_dwordx4 v[172:175], v186, s[24:27], s58 offen sc1
    v_exp_f32 v50, v50
    v_exp_f32 v51, v51
    v_exp_f32 v52, v52
    v_exp_f32 v53, v53
    v_exp_f32 v54, v54
    v_exp_f32 v55, v55
    v_exp_f32 v24, v24
    v_exp_f32 v25, v25
    s_waitcnt lgkmcnt(0)
    v_smfmac_f32_32x32x32_bf16 v[72:87], v[20:23], v[48:55], v3
    ds_read_b128 v[20:23], v2 offset:6656
    v_exp_f32 v26, v26
    v_exp_f32 v27, v27
    v_exp_f32 v28, v28
    v_mfma_f32_32x32x16_bf16 v[40:55], v[12:15], v[8:11], v[56:71]
    ds_read_b128 v[12:15], v1 offset:49152
    v_exp_f32 v29, v29
    v_exp_f32 v30, v30
    v_exp_f32 v31, v31
    v_exp_f32 v32, v32
    v_exp_f32 v33, v33
    v_smfmac_f32_32x32x32_bf16 v[72:87], v[16:19], v[24:31], v3
    ds_read_b128 v[16:19], v2 offset:7168
    s_add_u32 s58, s63, 1140224
    buffer_load_dwordx4 v[176:179], v185, s[24:27], s58 offen sc1
    v_exp_f32 v34, v34
    v_exp_f32 v35, v35
    v_exp_f32 v36, v36
    v_exp_f32 v37, v37
    v_exp_f32 v38, v38
    v_exp_f32 v39, v39
    v_exp_f32 v40, v40
    v_exp_f32 v41, v41
    s_waitcnt lgkmcnt(0)
    v_smfmac_f32_32x32x32_bf16 v[72:87], v[20:23], v[32:39], v3
    ds_read_b128 v[20:23], v2 offset:7680
    v_exp_f32 v42, v42
    v_exp_f32 v43, v43
    v_exp_f32 v44, v44
    v_mfma_f32_32x32x16_bf16 v[24:39], v[12:15], v[8:11], v[56:71]
    ds_read_b128 v[12:15], v1 offset:50176
    v_exp_f32 v45, v45
    v_exp_f32 v46, v46
    v_exp_f32 v47, v47
    v_exp_f32 v48, v48
    v_exp_f32 v49, v49
    v_smfmac_f32_32x32x32_bf16 v[72:87], v[16:19], v[40:47], v3
    ds_read_b128 v[16:19], v2 offset:8192
    buffer_load_dwordx4 v[180:183], v186, s[24:27], s58 offen sc1
    v_exp_f32 v50, v50
    v_exp_f32 v51, v51
    v_exp_f32 v52, v52
    v_exp_f32 v53, v53
    v_exp_f32 v54, v54
    v_exp_f32 v55, v55
    v_add_u32 v2, v4, v2
    v_exp_f32 v24, v24
    v_exp_f32 v25, v25
    s_waitcnt lgkmcnt(0)
    v_smfmac_f32_32x32x32_bf16 v[72:87], v[20:23], v[48:55], v3
    ds_read_b128 v[20:23], v2 offset:512
    v_exp_f32 v26, v26
    v_exp_f32 v27, v27
    v_exp_f32 v28, v28
    v_mfma_f32_32x32x16_bf16 v[40:55], v[12:15], v[8:11], v[56:71]
    ds_read_b128 v[12:15], v1 offset:51200
    v_exp_f32 v29, v29
    v_exp_f32 v30, v30
    v_exp_f32 v31, v31
    v_exp_f32 v32, v32
    v_exp_f32 v33, v33
    v_smfmac_f32_32x32x32_bf16 v[72:87], v[16:19], v[24:31], v3
    ds_read_b128 v[16:19], v2 offset:1024
    v_exp_f32 v34, v34
    v_exp_f32 v35, v35
    v_exp_f32 v36, v36
    v_exp_f32 v37, v37
    v_exp_f32 v38, v38
    v_exp_f32 v39, v39
    v_exp_f32 v40, v40
    v_exp_f32 v41, v41
    s_waitcnt lgkmcnt(0)
    v_smfmac_f32_32x32x32_bf16 v[72:87], v[20:23], v[32:39], v3
    ds_read_b128 v[20:23], v2 offset:1536
    v_exp_f32 v42, v42
    v_exp_f32 v43, v43
    v_exp_f32 v44, v44
    v_mfma_f32_32x32x16_bf16 v[24:39], v[12:15], v[8:11], v[56:71]
    ds_read_b128 v[12:15], v1 offset:52224
    s_setprio 2
    v_exp_f32 v45, v45
    v_exp_f32 v46, v46
    v_exp_f32 v47, v47
    v_exp_f32 v48, v48
    v_exp_f32 v49, v49
    v_smfmac_f32_32x32x32_bf16 v[72:87], v[16:19], v[40:47], v3
    ds_read_b128 v[16:19], v2 offset:2048
    v_exp_f32 v50, v50
    v_exp_f32 v51, v51
    v_exp_f32 v52, v52
    v_exp_f32 v53, v53
    v_exp_f32 v54, v54
    v_exp_f32 v55, v55
    v_exp_f32 v24, v24
    v_exp_f32 v25, v25
    s_waitcnt lgkmcnt(0)
    v_smfmac_f32_32x32x32_bf16 v[72:87], v[20:23], v[48:55], v3
    ds_read_b128 v[20:23], v2 offset:2560
    v_exp_f32 v26, v26
    v_exp_f32 v27, v27
    v_exp_f32 v28, v28
    v_mfma_f32_32x32x16_bf16 v[40:55], v[12:15], v[8:11], v[56:71]
    ds_read_b128 v[12:15], v1 offset:53248
    v_exp_f32 v29, v29
    v_exp_f32 v30, v30
    v_exp_f32 v31, v31
    v_exp_f32 v32, v32
    v_exp_f32 v33, v33
    v_smfmac_f32_32x32x32_bf16 v[72:87], v[16:19], v[24:31], v3
    ds_read_b128 v[16:19], v2 offset:3072
    v_exp_f32 v34, v34
    v_exp_f32 v35, v35
    v_exp_f32 v36, v36
    v_exp_f32 v37, v37
    v_exp_f32 v38, v38
    v_exp_f32 v39, v39
    v_exp_f32 v40, v40
    v_exp_f32 v41, v41
    s_waitcnt lgkmcnt(0)
    v_smfmac_f32_32x32x32_bf16 v[72:87], v[20:23], v[32:39], v3
    ds_read_b128 v[20:23], v2 offset:3584
    v_exp_f32 v42, v42
    v_exp_f32 v43, v43
    v_exp_f32 v44, v44
    v_mfma_f32_32x32x16_bf16 v[24:39], v[12:15], v[8:11], v[56:71]
    ds_read_b128 v[12:15], v1 offset:54272
    v_exp_f32 v45, v45
    v_exp_f32 v46, v46
    v_exp_f32 v47, v47
    v_exp_f32 v48, v48
    v_exp_f32 v49, v49
    v_smfmac_f32_32x32x32_bf16 v[72:87], v[16:19], v[40:47], v3
    ds_read_b128 v[16:19], v2 offset:4096
    v_exp_f32 v50, v50
    v_exp_f32 v51, v51
    v_exp_f32 v52, v52
    v_exp_f32 v53, v53
    v_exp_f32 v54, v54
    v_exp_f32 v55, v55
    v_exp_f32 v24, v24
    v_exp_f32 v25, v25
    s_waitcnt lgkmcnt(0)
    v_smfmac_f32_32x32x32_bf16 v[72:87], v[20:23], v[48:55], v3
    ds_read_b128 v[20:23], v2 offset:4608
    v_exp_f32 v26, v26
    v_exp_f32 v27, v27
    v_exp_f32 v28, v28
    v_mfma_f32_32x32x16_bf16 v[40:55], v[12:15], v[8:11], v[56:71]
    ds_read_b128 v[12:15], v1 offset:55296
    v_exp_f32 v29, v29
    v_exp_f32 v30, v30
    v_exp_f32 v31, v31
    v_exp_f32 v32, v32
    v_exp_f32 v33, v33
    v_smfmac_f32_32x32x32_bf16 v[72:87], v[16:19], v[24:31], v3
    ds_read_b128 v[16:19], v2 offset:5120
    v_exp_f32 v34, v34
    v_exp_f32 v35, v35
    v_exp_f32 v36, v36
    v_exp_f32 v37, v37
    v_exp_f32 v38, v38
    v_exp_f32 v39, v39
    v_exp_f32 v40, v40
    v_exp_f32 v41, v41
    s_waitcnt lgkmcnt(0)
    v_smfmac_f32_32x32x32_bf16 v[72:87], v[20:23], v[32:39], v3
    ds_read_b128 v[20:23], v2 offset:5632
    v_exp_f32 v42, v42
    v_exp_f32 v43, v43
    v_exp_f32 v44, v44
    v_mfma_f32_32x32x16_bf16 v[24:39], v[12:15], v[8:11], v[56:71]
    ds_read_b128 v[12:15], v1 offset:56320
    v_exp_f32 v45, v45
    v_exp_f32 v46, v46
    v_exp_f32 v47, v47
    v_exp_f32 v48, v48
    v_exp_f32 v49, v49
    v_smfmac_f32_32x32x32_bf16 v[72:87], v[16:19], v[40:47], v3
    ds_read_b128 v[16:19], v2 offset:6144
    v_exp_f32 v50, v50
    v_exp_f32 v51, v51
    v_exp_f32 v52, v52
    v_exp_f32 v53, v53
    v_exp_f32 v54, v54
    v_exp_f32 v55, v55
    v_exp_f32 v24, v24
    v_exp_f32 v25, v25
    s_waitcnt lgkmcnt(0)
    v_smfmac_f32_32x32x32_bf16 v[72:87], v[20:23], v[48:55], v3
    ds_read_b128 v[20:23], v2 offset:6656
    v_exp_f32 v26, v26
    v_exp_f32 v27, v27
    v_exp_f32 v28, v28
    v_mfma_f32_32x32x16_bf16 v[40:55], v[12:15], v[8:11], v[56:71]
    ds_read_b128 v[12:15], v1 offset:57344
    v_exp_f32 v29, v29
    v_exp_f32 v30, v30
    v_exp_f32 v31, v31
    v_exp_f32 v32, v32
    v_exp_f32 v33, v33
    v_smfmac_f32_32x32x32_bf16 v[72:87], v[16:19], v[24:31], v3
    ds_read_b128 v[16:19], v2 offset:7168
    v_exp_f32 v34, v34
    v_exp_f32 v35, v35
    v_exp_f32 v36, v36
    v_exp_f32 v37, v37
    v_exp_f32 v38, v38
    v_exp_f32 v39, v39
    v_exp_f32 v40, v40
    v_exp_f32 v41, v41
    s_waitcnt lgkmcnt(0)
    v_smfmac_f32_32x32x32_bf16 v[72:87], v[20:23], v[32:39], v3
    ds_read_b128 v[20:23], v2 offset:7680
    v_exp_f32 v42, v42
    v_exp_f32 v43, v43
    v_exp_f32 v44, v44
    v_mfma_f32_32x32x16_bf16 v[24:39], v[12:15], v[8:11], v[56:71]
    ds_read_b128 v[12:15], v1 offset:58368
    v_exp_f32 v45, v45
    v_exp_f32 v46, v46
    v_exp_f32 v47, v47
    v_exp_f32 v48, v48
    v_exp_f32 v49, v49
    v_smfmac_f32_32x32x32_bf16 v[72:87], v[16:19], v[40:47], v3
    ds_read_b128 v[16:19], v2 offset:8192
    v_exp_f32 v50, v50
    v_exp_f32 v51, v51
    v_exp_f32 v52, v52
    v_exp_f32 v53, v53
    v_exp_f32 v54, v54
    v_exp_f32 v55, v55
    v_add_u32 v2, v4, v2
    v_exp_f32 v24, v24
    v_exp_f32 v25, v25
    s_waitcnt lgkmcnt(0)
    v_smfmac_f32_32x32x32_bf16 v[72:87], v[20:23], v[48:55], v3
    ds_read_b128 v[20:23], v2 offset:512
    v_exp_f32 v26, v26
    v_exp_f32 v27, v27
    v_exp_f32 v28, v28
    v_mfma_f32_32x32x16_bf16 v[40:55], v[12:15], v[8:11], v[56:71]
    ds_read_b128 v[12:15], v1 offset:59392
    v_exp_f32 v29, v29
    v_exp_f32 v30, v30
    v_exp_f32 v31, v31
    v_exp_f32 v32, v32
    v_exp_f32 v33, v33
    v_smfmac_f32_32x32x32_bf16 v[72:87], v[16:19], v[24:31], v3
    ds_read_b128 v[16:19], v2 offset:1024
    v_exp_f32 v34, v34
    v_exp_f32 v35, v35
    v_exp_f32 v36, v36
    v_exp_f32 v37, v37
    v_exp_f32 v38, v38
    v_exp_f32 v39, v39
    v_exp_f32 v40, v40
    v_exp_f32 v41, v41
    s_waitcnt lgkmcnt(0)
    v_smfmac_f32_32x32x32_bf16 v[72:87], v[20:23], v[32:39], v3
    ds_read_b128 v[20:23], v2 offset:1536
    v_exp_f32 v42, v42
    v_exp_f32 v43, v43
    v_exp_f32 v44, v44
    v_mfma_f32_32x32x16_bf16 v[24:39], v[12:15], v[8:11], v[56:71]
    ds_read_b128 v[12:15], v1 offset:60416
    s_setprio 1
    v_exp_f32 v45, v45
    v_exp_f32 v46, v46
    v_exp_f32 v47, v47
    v_exp_f32 v48, v48
    v_exp_f32 v49, v49
    v_smfmac_f32_32x32x32_bf16 v[72:87], v[16:19], v[40:47], v3
    ds_read_b128 v[16:19], v2 offset:2048
    v_exp_f32 v50, v50
    v_exp_f32 v51, v51
    v_exp_f32 v52, v52
    v_exp_f32 v53, v53
    v_exp_f32 v54, v54
    v_exp_f32 v55, v55
    v_exp_f32 v24, v24
    v_exp_f32 v25, v25
    s_waitcnt lgkmcnt(0)
    v_smfmac_f32_32x32x32_bf16 v[72:87], v[20:23], v[48:55], v3
    ds_read_b128 v[20:23], v2 offset:2560
    v_exp_f32 v26, v26
    v_exp_f32 v27, v27
    v_exp_f32 v28, v28
    v_mfma_f32_32x32x16_bf16 v[40:55], v[12:15], v[8:11], v[56:71]
    ds_read_b128 v[12:15], v1 offset:61440
    v_exp_f32 v29, v29
    v_exp_f32 v30, v30
    v_exp_f32 v31, v31
    v_exp_f32 v32, v32
    v_exp_f32 v33, v33
    v_smfmac_f32_32x32x32_bf16 v[72:87], v[16:19], v[24:31], v3
    ds_read_b128 v[16:19], v2 offset:3072
    v_exp_f32 v34, v34
    v_exp_f32 v35, v35
    v_exp_f32 v36, v36
    v_exp_f32 v37, v37
    v_exp_f32 v38, v38
    v_exp_f32 v39, v39
    v_exp_f32 v40, v40
    v_exp_f32 v41, v41
    s_waitcnt lgkmcnt(0)
    v_smfmac_f32_32x32x32_bf16 v[72:87], v[20:23], v[32:39], v3
    ds_read_b128 v[20:23], v2 offset:3584
    v_exp_f32 v42, v42
    v_exp_f32 v43, v43
    v_exp_f32 v44, v44
    v_mfma_f32_32x32x16_bf16 v[24:39], v[12:15], v[8:11], v[56:71]
    ds_read_b128 v[12:15], v1 offset:62464
    v_exp_f32 v45, v45
    v_exp_f32 v46, v46
    v_exp_f32 v47, v47
    v_exp_f32 v48, v48
    v_exp_f32 v49, v49
    v_smfmac_f32_32x32x32_bf16 v[72:87], v[16:19], v[40:47], v3
    ds_read_b128 v[16:19], v2 offset:4096
    s_mov_b32 exec_hi, 0
    buffer_store_dwordx2 v[220:221], v218, s[24:27], s73 offen sc1
    s_mov_b32 exec_hi, -1
    v_exp_f32 v50, v50
    v_exp_f32 v51, v51
    v_exp_f32 v52, v52
    v_exp_f32 v53, v53
    v_exp_f32 v54, v54
    v_exp_f32 v55, v55
    v_exp_f32 v24, v24
    v_exp_f32 v25, v25
    s_waitcnt lgkmcnt(0)
    v_smfmac_f32_32x32x32_bf16 v[72:87], v[20:23], v[48:55], v3
    ds_read_b128 v[20:23], v2 offset:4608
    v_exp_f32 v26, v26
    v_exp_f32 v27, v27
    v_exp_f32 v28, v28
    v_mfma_f32_32x32x16_bf16 v[40:55], v[12:15], v[8:11], v[56:71]
    ds_read_b128 v[12:15], v1 offset:63488
    v_exp_f32 v29, v29
    v_exp_f32 v30, v30
    v_exp_f32 v31, v31
    v_exp_f32 v32, v32
    v_exp_f32 v33, v33
    v_smfmac_f32_32x32x32_bf16 v[72:87], v[16:19], v[24:31], v3
    ds_read_b128 v[16:19], v2 offset:5120
    v_exp_f32 v34, v34
    v_exp_f32 v35, v35
    v_exp_f32 v36, v36
    v_exp_f32 v37, v37
    v_exp_f32 v38, v38
    v_exp_f32 v39, v39
    v_exp_f32 v40, v40
    v_exp_f32 v41, v41
    s_waitcnt lgkmcnt(0)
    v_smfmac_f32_32x32x32_bf16 v[72:87], v[20:23], v[32:39], v3
    ds_read_b128 v[20:23], v2 offset:5632
    v_exp_f32 v42, v42
    v_exp_f32 v43, v43
    v_exp_f32 v44, v44
    v_mfma_f32_32x32x16_bf16 v[24:39], v[12:15], v[8:11], v[56:71]
    ds_read_b128 v[12:15], v1 offset:64512
    v_exp_f32 v45, v45
    v_exp_f32 v46, v46
    v_exp_f32 v47, v47
    v_exp_f32 v48, v48
    v_exp_f32 v49, v49
    v_smfmac_f32_32x32x32_bf16 v[72:87], v[16:19], v[40:47], v3
    ds_read_b128 v[16:19], v2 offset:6144
    v_exp_f32 v50, v50
    v_exp_f32 v51, v51
    v_exp_f32 v52, v52
    v_exp_f32 v53, v53
    v_exp_f32 v54, v54
    v_exp_f32 v55, v55
    v_exp_f32 v24, v24
    v_exp_f32 v25, v25
    s_waitcnt lgkmcnt(0)
    v_smfmac_f32_32x32x32_bf16 v[72:87], v[20:23], v[48:55], v3
    ds_read_b128 v[20:23], v2 offset:6656
    v_exp_f32 v26, v26
    v_exp_f32 v27, v27
    v_exp_f32 v28, v28
    v_mfma_f32_32x32x16_bf16 v[40:55], v[12:15], v[8:11], v[56:71]
    v_exp_f32 v29, v29
    v_exp_f32 v30, v30
    v_exp_f32 v31, v31
    v_exp_f32 v32, v32
    v_exp_f32 v33, v33
    v_smfmac_f32_32x32x32_bf16 v[72:87], v[16:19], v[24:31], v3
    ds_read_b128 v[16:19], v2 offset:7168
    v_exp_f32 v34, v34
    v_exp_f32 v35, v35
    v_exp_f32 v36, v36
    v_exp_f32 v37, v37
    v_exp_f32 v38, v38
    v_exp_f32 v39, v39
    v_exp_f32 v40, v40
    v_exp_f32 v41, v41
    s_waitcnt lgkmcnt(0)
    v_smfmac_f32_32x32x32_bf16 v[72:87], v[20:23], v[32:39], v3
    ds_read_b128 v[20:23], v2 offset:7680
    v_exp_f32 v42, v42
    v_exp_f32 v43, v43
    v_exp_f32 v44, v44
    s_setprio 0
    v_exp_f32 v45, v45
    v_exp_f32 v46, v46
    v_exp_f32 v47, v47
    v_exp_f32 v48, v48
    v_exp_f32 v49, v49
    v_smfmac_f32_32x32x32_bf16 v[72:87], v[16:19], v[40:47], v3
    v_exp_f32 v50, v50
    v_exp_f32 v51, v51
    v_exp_f32 v52, v52
    v_exp_f32 v53, v53
    v_exp_f32 v54, v54
    v_exp_f32 v55, v55
F_attn_done:
    s_waitcnt lgkmcnt(0)
    v_smfmac_f32_32x32x32_bf16 v[72:87], v[20:23], v[48:55], v3
    s_cmp_lg_u32 s65, 0
    s_nop 9
    s_cbranch_scc1 F_fin
    v_add_f32 v5, abs(v72), abs(v73)
    v_add_f32 v5, v5, abs(v74)
    v_add_f32 v5, v5, abs(v75)
    v_add_f32 v5, v5, abs(v76)
    v_add_f32 v5, v5, abs(v77)
    v_add_f32 v5, v5, abs(v78)
    v_add_f32 v5, v5, abs(v79)
    v_mov_b32 v6, 0x7b800000
    v_cmp_nlt_f32 vcc, v80, v6
    v_mov_b32 v6, 0x7f000000
    v_cmp_nlt_f32 s[60:61], v5, v6
    s_nop 1
    s_or_b64 vcc, vcc, s[60:61]
    s_cbranch_scc1 F_fallback
F_fin:
    v_rcp_f32 v5, v80
    s_nop 0
    v_mul_f32 v72, v72, v5
    v_mul_f32 v73, v73, v5
    v_mul_f32 v74, v74, v5
    v_mul_f32 v75, v75, v5
    v_mul_f32 v76, v76, v5
    v_mul_f32 v77, v77, v5
    v_mul_f32 v78, v78, v5
    v_mul_f32 v79, v79, v5
    v_cvt_pk_bf16_f32 v72, v72, v73
    v_cvt_pk_bf16_f32 v73, v74, v75
    v_cvt_pk_bf16_f32 v74, v76, v77
    v_cvt_pk_bf16_f32 v75, v78, v79
    v_min_u32 v72, -2, v72
    v_min_u32 v73, -2, v73
    v_min_u32 v74, -2, v74
    v_min_u32 v75, -2, v75
    buffer_store_dwordx4 v[72:75], v7, s[24:27], s72 offen sc1
    v_and_b32 v2, 31, v0
    v_bfe_u32 v3, v0, 5, 1
    s_cmp_lt_u32 s8, 4
    s_cbranch_scc1 F_tailA
    s_waitcnt vmcnt(2)
    s_barrier
    v_mfma_f32_32x32x16_bf16 v[24:39], v[88:91], v[120:123], 0
    v_mfma_f32_32x32x16_bf16 v[40:55], v[88:91], v[124:127], 0
    v_mfma_f32_32x32x16_bf16 v[24:39], v[92:95], v[128:131], v[24:39]
    v_mfma_f32_32x32x16_bf16 v[40:55], v[92:95], v[132:135], v[40:55]
    v_mfma_f32_32x32x16_bf16 v[24:39], v[96:99], v[136:139], v[24:39]
    v_mfma_f32_32x32x16_bf16 v[40:55], v[96:99], v[140:143], v[40:55]
    v_mfma_f32_32x32x16_bf16 v[24:39], v[100:103], v[144:147], v[24:39]
    v_mfma_f32_32x32x16_bf16 v[40:55], v[100:103], v[148:151], v[40:55]
    v_mfma_f32_32x32x16_bf16 v[24:39], v[104:107], v[152:155], v[24:39]
    v_mfma_f32_32x32x16_bf16 v[40:55], v[104:107], v[156:159], v[40:55]
    v_mfma_f32_32x32x16_bf16 v[24:39], v[108:111], v[160:163], v[24:39]
    v_mfma_f32_32x32x16_bf16 v[40:55], v[108:111], v[164:167], v[40:55]
    v_mfma_f32_32x32x16_bf16 v[24:39], v[112:115], v[168:171], v[24:39]
    v_mfma_f32_32x32x16_bf16 v[40:55], v[112:115], v[172:175], v[40:55]
    v_mfma_f32_32x32x16_bf16 v[24:39], v[116:119], v[176:179], v[24:39]
    v_mfma_f32_32x32x16_bf16 v[40:55], v[116:119], v[180:183], v[40:55]
    s_sub_u32 s60, s8, 4
    s_lshl_b32 s61, s60, 12
    s_add_u32 s61, s61, 141312
    v_add_u32 v11, s61, v7
    s_xor_b32 s61, s60, 2
    s_lshl_b32 s61, s61, 12
    s_add_u32 s61, s61, 141312
    v_add_u32 v12, s61, v7
    s_lshl_b32 s61, s8, 2
    s_add_u32 s61, s61, 157712
    v_mov_b32 v8, s61
    v_xor_b32 v9, 8, v8
    v_lshlrev_b32 v4, 2, v2
    v_lshl_add_u32 v4, v3, 18, v4
    s_and_b32 s61, s60, 1
    s_lshl_b32 s61, s61, 1
    s_lshr_b32 s60, s60, 1
    s_add_u32 s61, s61, s60
    s_lshl_b32 s61, s61, 9
    s_add_u32 s61, s61, s52
    s_lshl_b32 s61, s61, 11
    s_lshl_b32 s60, s53, 7
    s_add_u32 s61, s61, s60
    ds_write_b128 v11, v[32:35] offset:0
    ds_write_b128 v11, v[36:39] offset:1024
    ds_write_b128 v11, v[48:51] offset:2048
    ds_write_b128 v11, v[52:55] offset:3072
    ds_write_b32 v8, v8
F_xwait:
    ds_read_b32 v10, v9
    s_waitcnt lgkmcnt(0)
    v_cmp_eq_u32 vcc, 0, v10
    s_nop 0
    s_cbranch_vccnz F_xwait
    ds_read_b128 v[56:59], v12 offset:0
    ds_read_b128 v[60:63], v12 offset:1024
    ds_read_b128 v[64:67], v12 offset:2048
    ds_read_b128 v[68:71], v12 offset:3072
    s_waitcnt lgkmcnt(0)
    v_add_f32 v24, v24, v56
    v_add_f32 v40, v40, v64
    v_cvt_pk_bf16_f32 v72, v24, v40
    v_add_f32 v25, v25, v57
    v_add_f32 v41, v41, v65
    v_cvt_pk_bf16_f32 v73, v25, v41
    v_add_f32 v26, v26, v58
    v_add_f32 v42, v42, v66
    v_cvt_pk_bf16_f32 v74, v26, v42
    v_add_f32 v27, v27, v59
    v_add_f32 v43, v43, v67
    v_cvt_pk_bf16_f32 v75, v27, v43
    v_add_f32 v28, v28, v60
    v_add_f32 v44, v44, v68
    v_cvt_pk_bf16_f32 v76, v28, v44
    v_add_f32 v29, v29, v61
    v_add_f32 v45, v45, v69
    v_cvt_pk_bf16_f32 v77, v29, v45
    v_add_f32 v30, v30, v62
    v_add_f32 v46, v46, v70
    v_cvt_pk_bf16_f32 v78, v30, v46
    v_add_f32 v31, v31, v63
    v_add_f32 v47, v47, v71
    v_cvt_pk_bf16_f32 v79, v31, v47
    s_add_u32 s60, s61, 0
    buffer_store_dword v72, v4, s[20:23], s60 offen sc1
    s_add_u32 s60, s61, 65536
    buffer_store_dword v73, v4, s[20:23], s60 offen sc1
    s_add_u32 s60, s61, 131072
    buffer_store_dword v74, v4, s[20:23], s60 offen sc1
    s_add_u32 s60, s61, 196608
    buffer_store_dword v75, v4, s[20:23], s60 offen sc1
    s_add_u32 s60, s61, 524288
    buffer_store_dword v76, v4, s[20:23], s60 offen sc1
    s_add_u32 s60, s61, 589824
    buffer_store_dword v77, v4, s[20:23], s60 offen sc1
    s_add_u32 s60, s61, 655360
    buffer_store_dword v78, v4, s[20:23], s60 offen sc1
    s_add_u32 s60, s61, 720896
    buffer_store_dword v79, v4, s[20:23], s60 offen sc1
    s_branch F_done
F_tailA:
    s_lshl_b32 s60, s51, 3
    s_lshr_b32 s61, s50, 2
    s_add_u32 s60, s60, s61
    s_add_u32 s59, s61, s51
    s_and_b32 s59, s59, 7
    s_lshl_b32 s59, s59, 12
    s_lshl_b32 s58, s60, 15
    s_lshl_b32 s61, s8, 13
    s_add_u32 s58, s58, s61
    s_xor_b32 s58, s58, s59
    s_add_u32 s58, s58, 6291456
    s_xor_b32 s59, s58, 4096
    s_mov_b32 s64, 12
    s_mov_b32 s62, 0
    s_waitcnt vmcnt(1)
    v_add_u32 v12, s61, v7
    v_and_b32 v11, 7, v0
    v_lshlrev_b32 v11, 2, v11
    v_add_u32 v11, 157696, v11
    s_lshl_b32 s61, s8, 3
    s_add_u32 s61, s61, 157696
    v_mov_b32 v10, s61
    v_lshlrev_b32 v4, 11, v2
    v_lshl_add_u32 v4, v3, 5, v4
    s_lshl_b32 s60, s60, 16
    s_and_b32 s61, s50, 3
    s_lshl_b32 s61, s61, 2
    s_add_u32 s61, s61, s8
    s_lshl_b32 s61, s61, 6
    s_add_u32 s60, s60, s61
    s_add_u32 s60, s60, 1024
    s_mov_b32 s66, 0
    v_mov_b32 v24, 0
    v_mov_b32 v25, 0
    v_mov_b32 v26, 0
    v_mov_b32 v27, 0
    v_mov_b32 v28, 0
    v_mov_b32 v29, 0
    v_mov_b32 v30, 0
    v_mov_b32 v31, 0
    v_mov_b32 v32, 0
    v_mov_b32 v33, 0
    v_mov_b32 v34, 0
    v_mov_b32 v35, 0
    v_mov_b32 v36, 0
    v_mov_b32 v37, 0
    v_mov_b32 v38, 0
    v_mov_b32 v39, 0
    s_barrier
    v_cmp_ne_u64 vcc, s[48:49], v[216:217]
    s_cmp_lt_u32 s62, 262144
    s_cselect_b32 s63, vcc_lo, 0
    s_bitcmp1_b32 s64, 2
    s_cbranch_scc0 F_f00
    s_and_b32 s57, s63, 15
    s_cbranch_scc1 F_f00
    buffer_load_dwordx4 v[40:43], v7, s[24:27], s58 offen offset:0 sc1
    buffer_load_dwordx4 v[44:47], v7, s[24:27], s58 offen offset:1024 sc1
    buffer_load_dwordx4 v[48:51], v7, s[24:27], s58 offen offset:2048 sc1
    buffer_load_dwordx4 v[52:55], v7, s[24:27], s58 offen offset:3072 sc1
    s_xor_b32 s64, s64, 5
F_f00:
    s_bitcmp1_b32 s64, 3
    s_cbranch_scc0 F_f01
    s_and_b32 s57, s63, 240
    s_cbranch_scc1 F_f01
    buffer_load_dwordx4 v[56:59], v7, s[24:27], s59 offen offset:0 sc1
    buffer_load_dwordx4 v[60:63], v7, s[24:27], s59 offen offset:1024 sc1
    buffer_load_dwordx4 v[64:67], v7, s[24:27], s59 offen offset:2048 sc1
    buffer_load_dwordx4 v[68:71], v7, s[24:27], s59 offen offset:3072 sc1
    s_xor_b32 s64, s64, 10
F_f01:
    s_and_b32 s57, s64, 12
    s_cbranch_scc0 F_round
    buffer_load_dwordx2 v[216:217], v218, s[24:27], 0 offen sc1
F_round:
    s_add_u32 s62, s62, 1
    s_waitcnt vmcnt(0)
    s_bitcmp1_b32 s64, 0
    s_cbranch_scc0 F_chk0
    v_max3_u32 v8, v40, v41, v42
    v_max3_u32 v8, v8, v43, v44
    v_max3_u32 v8, v8, v45, v46
    v_max3_u32 v8, v8, v47, v48
    v_max3_u32 v8, v8, v49, v50
    v_max3_u32 v8, v8, v51, v52
    v_max3_u32 v8, v8, v53, v54
    v_max_u32 v8, v8, v55
    v_cmp_eq_u32 vcc, -1, v8
    s_cmp_lt_u32 s62, 262144
    s_cselect_b64 vcc, vcc, 0
    s_cbranch_vccz F_pub0
    buffer_load_dwordx4 v[40:43], v7, s[24:27], s58 offen offset:0 sc1
    buffer_load_dwordx4 v[44:47], v7, s[24:27], s58 offen offset:1024 sc1
    buffer_load_dwordx4 v[48:51], v7, s[24:27], s58 offen offset:2048 sc1
    buffer_load_dwordx4 v[52:55], v7, s[24:27], s58 offen offset:3072 sc1
    s_branch F_chk0
F_pub0:
    ds_write_b128 v12, v[40:43] offset:0
    ds_write_b128 v12, v[44:47] offset:1024
    ds_write_b128 v12, v[48:51] offset:2048
    ds_write_b128 v12, v[52:55] offset:3072
    ds_write_b32 v10, v10 offset:0
    s_bitset0_b32 s64, 0
F_chk0:
    s_bitcmp1_b32 s64, 1
    s_cbranch_scc0 F_chk1
    v_max3_u32 v8, v56, v57, v58
    v_max3_u32 v8, v8, v59, v60
    v_max3_u32 v8, v8, v61, v62
    v_max3_u32 v8, v8, v63, v64
    v_max3_u32 v8, v8, v65, v66
    v_max3_u32 v8, v8, v67, v68
    v_max3_u32 v8, v8, v69, v70
    v_max_u32 v8, v8, v71
    v_cmp_eq_u32 vcc, -1, v8
    s_cmp_lt_u32 s62, 262144
    s_cselect_b64 vcc, vcc, 0
    s_cbranch_vccz F_pub1
    buffer_load_dwordx4 v[56:59], v7, s[24:27], s59 offen offset:0 sc1
    buffer_load_dwordx4 v[60:63], v7, s[24:27], s59 offen offset:1024 sc1
    buffer_load_dwordx4 v[64:67], v7, s[24:27], s59 offen offset:2048 sc1
    buffer_load_dwordx4 v[68:71], v7, s[24:27], s59 offen offset:3072 sc1
    s_branch F_chk1
F_pub1:
    ds_write_b128 v12, v[56:59] offset:4096
    ds_write_b128 v12, v[60:63] offset:5120
    ds_write_b128 v12, v[64:67] offset:6144
    ds_write_b128 v12, v[68:71] offset:7168
    ds_write_b32 v10, v10 offset:4
    s_bitset0_b32 s64, 1
F_chk1:
    s_and_b32 s57, s64, 12
    s_cbranch_scc0 F_noflag
    v_cmp_ne_u64 vcc, s[48:49], v[216:217]
    s_cmp_lt_u32 s62, 262144
    s_cselect_b32 s63, vcc_lo, 0
    s_bitcmp1_b32 s64, 2
    s_cbranch_scc0 F_f10
    s_and_b32 s57, s63, 15
    s_cbranch_scc1 F_f10
    buffer_load_dwordx4 v[40:43], v7, s[24:27], s58 offen offset:0 sc1
    buffer_load_dwordx4 v[44:47], v7, s[24:27], s58 offen offset:1024 sc1
    buffer_load_dwordx4 v[48:51], v7, s[24:27], s58 offen offset:2048 sc1
    buffer_load_dwordx4 v[52:55], v7, s[24:27], s58 offen offset:3072 sc1
    s_xor_b32 s64, s64, 5
F_f10:
    s_bitcmp1_b32 s64, 3
    s_cbranch_scc0 F_f11
    s_and_b32 s57, s63, 240
    s_cbranch_scc1 F_f11
    buffer_load_dwordx4 v[56:59], v7, s[24:27], s59 offen offset:0 sc1
    buffer_load_dwordx4 v[60:63], v7, s[24:27], s59 offen offset:1024 sc1
    buffer_load_dwordx4 v[64:67], v7, s[24:27], s59 offen offset:2048 sc1
    buffer_load_dwordx4 v[68:71], v7, s[24:27], s59 offen offset:3072 sc1
    s_xor_b32 s64, s64, 10
F_f11:
    s_and_b32 s57, s64, 12
    s_cbranch_scc0 F_noflag
    buffer_load_dwordx2 v[216:217], v218, s[24:27], 0 offen sc1
F_noflag:
    ds_read_b32 v8, v11
    s_waitcnt lgkmcnt(0)
    v_cmp_ne_u32 vcc, 0, v8
    s_nop 0
    s_andn2_b32 s67, vcc_lo, s66
    s_and_b32 s67, s67, 0xff
    s_cbranch_scc0 F_round
    s_and_b32 s57, s67, 15
    s_cselect_b32 s57, s57, s67
    s_cmp_eq_u32 s64, 0
    s_cselect_b32 s67, s67, s57
    s_or_b32 s66, s66, s67
    s_ff1_i32_b32 s61, s67
    s_lshl_b32 s61, s61, 12
    v_add_u32 v9, s61, v7
    ds_read_b128 v[72:75], v9 offset:0
    ds_read_b128 v[76:79], v9 offset:1024
    ds_read_b128 v[80:83], v9 offset:2048
    ds_read_b128 v[84:87], v9 offset:3072
    s_bitcmp1_b32 s67, 0
    s_cbranch_scc0 F_grp0
    s_waitcnt lgkmcnt(3)
    v_mfma_f32_32x32x16_bf16 v[24:39], v[88:91], v[72:75], v[24:39]
    s_bitset0_b32 s67, 0
    s_ff1_i32_b32 s61, s67
    s_and_b32 s61, s61, 7
    v_lshl_add_u32 v9, s61, 12, v7
    ds_read_b128 v[72:75], v9 offset:0
    s_waitcnt lgkmcnt(3)
    v_mfma_f32_32x32x16_bf16 v[24:39], v[92:95], v[76:79], v[24:39]
    ds_read_b128 v[76:79], v9 offset:1024
    s_waitcnt lgkmcnt(3)
    v_mfma_f32_32x32x16_bf16 v[24:39], v[96:99], v[80:83], v[24:39]
    ds_read_b128 v[80:83], v9 offset:2048
    s_waitcnt lgkmcnt(3)
    v_mfma_f32_32x32x16_bf16 v[24:39], v[100:103], v[84:87], v[24:39]
    ds_read_b128 v[84:87], v9 offset:3072
F_grp0:
    s_bitcmp1_b32 s67, 1
    s_cbranch_scc0 F_grp1
    s_waitcnt lgkmcnt(3)
    v_mfma_f32_32x32x16_bf16 v[24:39], v[104:107], v[72:75], v[24:39]
    s_bitset0_b32 s67, 1
    s_ff1_i32_b32 s61, s67
    s_and_b32 s61, s61, 7
    v_lshl_add_u32 v9, s61, 12, v7
    ds_read_b128 v[72:75], v9 offset:0
    s_waitcnt lgkmcnt(3)
    v_mfma_f32_32x32x16_bf16 v[24:39], v[108:111], v[76:79], v[24:39]
    ds_read_b128 v[76:79], v9 offset:1024
    s_waitcnt lgkmcnt(3)
    v_mfma_f32_32x32x16_bf16 v[24:39], v[112:115], v[80:83], v[24:39]
    ds_read_b128 v[80:83], v9 offset:2048
    s_waitcnt lgkmcnt(3)
    v_mfma_f32_32x32x16_bf16 v[24:39], v[116:119], v[84:87], v[24:39]
    ds_read_b128 v[84:87], v9 offset:3072
F_grp1:
    s_bitcmp1_b32 s67, 2
    s_cbranch_scc0 F_grp2
    s_waitcnt lgkmcnt(3)
    v_mfma_f32_32x32x16_bf16 v[24:39], v[120:123], v[72:75], v[24:39]
    s_bitset0_b32 s67, 2
    s_ff1_i32_b32 s61, s67
    s_and_b32 s61, s61, 7
    v_lshl_add_u32 v9, s61, 12, v7
    ds_read_b128 v[72:75], v9 offset:0
    s_waitcnt lgkmcnt(3)
    v_mfma_f32_32x32x16_bf16 v[24:39], v[124:127], v[76:79], v[24:39]
    ds_read_b128 v[76:79], v9 offset:1024
    s_waitcnt lgkmcnt(3)
    v_mfma_f32_32x32x16_bf16 v[24:39], v[128:131], v[80:83], v[24:39]
    ds_read_b128 v[80:83], v9 offset:2048
    s_waitcnt lgkmcnt(3)
    v_mfma_f32_32x32x16_bf16 v[24:39], v[132:135], v[84:87], v[24:39]
    ds_read_b128 v[84:87], v9 offset:3072
F_grp2:
    s_bitcmp1_b32 s67, 3
    s_cbranch_scc0 F_grp3
    s_waitcnt lgkmcnt(3)
    v_mfma_f32_32x32x16_bf16 v[24:39], v[136:139], v[72:75], v[24:39]
    s_bitset0_b32 s67, 3
    s_ff1_i32_b32 s61, s67
    s_and_b32 s61, s61, 7
    v_lshl_add_u32 v9, s61, 12, v7
    ds_read_b128 v[72:75], v9 offset:0
    s_waitcnt lgkmcnt(3)
    v_mfma_f32_32x32x16_bf16 v[24:39], v[140:143], v[76:79], v[24:39]
    ds_read_b128 v[76:79], v9 offset:1024
    s_waitcnt lgkmcnt(3)
    v_mfma_f32_32x32x16_bf16 v[24:39], v[144:147], v[80:83], v[24:39]
    ds_read_b128 v[80:83], v9 offset:2048
    s_waitcnt lgkmcnt(3)
    v_mfma_f32_32x32x16_bf16 v[24:39], v[148:151], v[84:87], v[24:39]
    ds_read_b128 v[84:87], v9 offset:3072
F_grp3:
    s_bitcmp1_b32 s67, 4
    s_cbranch_scc0 F_grp4
    s_waitcnt lgkmcnt(3)
    v_mfma_f32_32x32x16_bf16 v[24:39], v[152:155], v[72:75], v[24:39]
    s_bitset0_b32 s67, 4
    s_ff1_i32_b32 s61, s67
    s_and_b32 s61, s61, 7
    v_lshl_add_u32 v9, s61, 12, v7
    ds_read_b128 v[72:75], v9 offset:0
    s_waitcnt lgkmcnt(3)
    v_mfma_f32_32x32x16_bf16 v[24:39], v[156:159], v[76:79], v[24:39]
    ds_read_b128 v[76:79], v9 offset:1024
    s_waitcnt lgkmcnt(3)
    v_mfma_f32_32x32x16_bf16 v[24:39], v[160:163], v[80:83], v[24:39]
    ds_read_b128 v[80:83], v9 offset:2048
    s_waitcnt lgkmcnt(3)
    v_mfma_f32_32x32x16_bf16 v[24:39], v[164:167], v[84:87], v[24:39]
    ds_read_b128 v[84:87], v9 offset:3072
F_grp4:
    s_bitcmp1_b32 s67, 5
    s_cbranch_scc0 F_grp5
    s_waitcnt lgkmcnt(3)
    v_mfma_f32_32x32x16_bf16 v[24:39], v[168:171], v[72:75], v[24:39]
    s_bitset0_b32 s67, 5
    s_ff1_i32_b32 s61, s67
    s_and_b32 s61, s61, 7
    v_lshl_add_u32 v9, s61, 12, v7
    ds_read_b128 v[72:75], v9 offset:0
    s_waitcnt lgkmcnt(3)
    v_mfma_f32_32x32x16_bf16 v[24:39], v[172:175], v[76:79], v[24:39]
    ds_read_b128 v[76:79], v9 offset:1024
    s_waitcnt lgkmcnt(3)
    v_mfma_f32_32x32x16_bf16 v[24:39], v[176:179], v[80:83], v[24:39]
    ds_read_b128 v[80:83], v9 offset:2048
    s_waitcnt lgkmcnt(3)
    v_mfma_f32_32x32x16_bf16 v[24:39], v[180:183], v[84:87], v[24:39]
    ds_read_b128 v[84:87], v9 offset:3072
F_grp5:
    s_bitcmp1_b32 s67, 6
    s_cbranch_scc0 F_grp6
    s_waitcnt lgkmcnt(3)
    v_mfma_f32_32x32x16_bf16 v[24:39], v[184:187], v[72:75], v[24:39]
    s_bitset0_b32 s67, 6
    s_ff1_i32_b32 s61, s67
    s_and_b32 s61, s61, 7
    v_lshl_add_u32 v9, s61, 12, v7
    ds_read_b128 v[72:75], v9 offset:0
    s_waitcnt lgkmcnt(3)
    v_mfma_f32_32x32x16_bf16 v[24:39], v[188:191], v[76:79], v[24:39]
    ds_read_b128 v[76:79], v9 offset:1024
    s_waitcnt lgkmcnt(3)
    v_mfma_f32_32x32x16_bf16 v[24:39], v[192:195], v[80:83], v[24:39]
    ds_read_b128 v[80:83], v9 offset:2048
    s_waitcnt lgkmcnt(3)
    v_mfma_f32_32x32x16_bf16 v[24:39], v[196:199], v[84:87], v[24:39]
    ds_read_b128 v[84:87], v9 offset:3072
F_grp6:
    s_bitcmp1_b32 s67, 7
    s_cbranch_scc0 F_grp7
    s_waitcnt lgkmcnt(3)
    v_mfma_f32_32x32x16_bf16 v[24:39], v[200:203], v[72:75], v[24:39]
    s_bitset0_b32 s67, 7
    s_ff1_i32_b32 s61, s67
    s_and_b32 s61, s61, 7
    v_lshl_add_u32 v9, s61, 12, v7
    ds_read_b128 v[72:75], v9 offset:0
    s_waitcnt lgkmcnt(3)
    v_mfma_f32_32x32x16_bf16 v[24:39], v[204:207], v[76:79], v[24:39]
    ds_read_b128 v[76:79], v9 offset:1024
    s_waitcnt lgkmcnt(3)
    v_mfma_f32_32x32x16_bf16 v[24:39], v[208:211], v[80:83], v[24:39]
    ds_read_b128 v[80:83], v9 offset:2048
    s_waitcnt lgkmcnt(3)
    v_mfma_f32_32x32x16_bf16 v[24:39], v[212:215], v[84:87], v[24:39]
    ds_read_b128 v[84:87], v9 offset:3072
F_grp7:
    s_cmp_lg_u32 s66, 0xff
    s_cbranch_scc1 F_round
    s_nop 8
    v_cvt_pk_bf16_f32 v40, v24, v25
    v_cvt_pk_bf16_f32 v41, v26, v27
    v_cvt_pk_bf16_f32 v42, v28, v29
    v_cvt_pk_bf16_f32 v43, v30, v31
    v_cvt_pk_bf16_f32 v44, v32, v33
    v_cvt_pk_bf16_f32 v45, v34, v35
    v_cvt_pk_bf16_f32 v46, v36, v37
    v_cvt_pk_bf16_f32 v47, v38, v39
    buffer_store_dwordx4 v[40:43], v4, s[20:23], s60 offen
    buffer_store_dwordx4 v[44:47], v4, s[20:23], s60 offen offset:16
F_done:
F_end:
    s_endpgm
F_fallback:
    v_mov_b32 v1, v7
    v_and_b32 v5, 0xf0, v7
    v_lshrrev_b32 v6, 1, v7
    v_and_b32 v6, 0x100, v6
    v_or_b32 v5, v5, v6
    v_and_b32 v6, 0x100, v7
    v_lshlrev_b32 v6, 8, v6
    v_add_u32 v5, v5, v6
    v_add_u32 v2, 65536, v5
    v_lshrrev_b32 v6, 3, v6
    v_sub_u32 v4, 0x2000, v6
    v_mov_b32 v5, 0xff800000
    s_movk_i32 s66, 64
F_maxloop:
    ds_read_b128 v[12:15], v1
    v_add_u32 v1, 0x400, v1
    s_waitcnt lgkmcnt(0)
    v_mfma_f32_32x32x16_bf16 v[24:39], v[12:15], v[8:11], 0
    s_nop 12
    v_max3_f32 v5, v5, v24, v25
    v_max3_f32 v5, v5, v26, v27
    v_max3_f32 v5, v5, v28, v29
    v_max3_f32 v5, v5, v30, v31
    v_max3_f32 v5, v5, v32, v33
    v_max3_f32 v5, v5, v34, v35
    v_max3_f32 v5, v5, v36, v37
    v_max3_f32 v5, v5, v38, v39
    s_sub_u32 s66, s66, 1
    s_cmp_lg_u32 s66, 0
    s_cbranch_scc1 F_maxloop
    v_mov_b32 v6, v5
    s_nop 1
    v_permlane32_swap_b32 v5, v6
    s_nop 1
    v_max_f32 v5, v5, v6
    v_sub_f32 v56, 0x80000000, v5
    v_mov_b32 v57, v56
    v_mov_b64 v[58:59], v[56:57]
    v_mov_b64 v[60:61], v[56:57]
    v_mov_b64 v[62:63], v[56:57]
    v_mov_b64 v[64:65], v[56:57]
    v_mov_b64 v[66:67], v[56:57]
    v_mov_b64 v[68:69], v[56:57]
    v_mov_b64 v[70:71], v[56:57]
    v_mov_b32 v1, v7
    ds_read_b128 v[12:15], v1
    v_mov_b32 v72, 0
    v_mov_b32 v73, 0
    v_mov_b32 v74, 0
    v_mov_b32 v75, 0
    v_mov_b32 v76, 0
    v_mov_b32 v77, 0
    v_mov_b32 v78, 0
    v_mov_b32 v79, 0
    v_mov_b32 v80, 0
    v_mov_b32 v81, 0
    v_mov_b32 v82, 0
    v_mov_b32 v83, 0
    v_mov_b32 v84, 0
    v_mov_b32 v85, 0
    v_mov_b32 v86, 0
    v_mov_b32 v87, 0
    v_mov_b32 v48, 0
    v_mov_b32 v49, 0
    v_mov_b32 v50, 0
    v_mov_b32 v51, 0
    v_mov_b32 v52, 0
    v_mov_b32 v53, 0
    v_mov_b32 v54, 0
    v_mov_b32 v55, 0
    v_mov_b32 v20, 0
    v_mov_b32 v21, 0
    v_mov_b32 v22, 0
    v_mov_b32 v23, 0
    s_waitcnt lgkmcnt(0)
    v_mfma_f32_32x32x16_bf16 v[24:39], v[12:15], v[8:11], v[56:71]
    ds_read_b128 v[12:15], v1 offset:1024
    ds_read_b128 v[16:19], v2
    s_nop 11
    s_mov_b32 s65, 1
    s_movk_i32 s66, 8
.p2align 6
F_loop:
    v_exp_f32 v24, v24
    v_exp_f32 v25, v25
    s_waitcnt lgkmcnt(0)
    v_smfmac_f32_32x32x32_bf16 v[72:87], v[20:23], v[48:55], v3
    ds_read_b128 v[20:23], v2 offset:512
    v_exp_f32 v26, v26
    v_exp_f32 v27, v27
    v_exp_f32 v28, v28
    v_mfma_f32_32x32x16_bf16 v[40:55], v[12:15], v[8:11], v[56:71]
    ds_read_b128 v[12:15], v1 offset:2048
    v_exp_f32 v29, v29
    v_exp_f32 v30, v30
    v_exp_f32 v31, v31
    v_exp_f32 v32, v32
    v_exp_f32 v33, v33
    v_smfmac_f32_32x32x32_bf16 v[72:87], v[16:19], v[24:31], v3
    ds_read_b128 v[16:19], v2 offset:1024
    v_exp_f32 v34, v34
    v_exp_f32 v35, v35
    v_exp_f32 v36, v36
    v_exp_f32 v37, v37
    v_exp_f32 v38, v38
    v_exp_f32 v39, v39
    v_exp_f32 v40, v40
    v_exp_f32 v41, v41
    s_waitcnt lgkmcnt(0)
    v_smfmac_f32_32x32x32_bf16 v[72:87], v[20:23], v[32:39], v3
    ds_read_b128 v[20:23], v2 offset:1536
    v_exp_f32 v42, v42
    v_exp_f32 v43, v43
    v_exp_f32 v44, v44
    v_mfma_f32_32x32x16_bf16 v[24:39], v[12:15], v[8:11], v[56:71]
    ds_read_b128 v[12:15], v1 offset:3072
    v_exp_f32 v45, v45
    v_exp_f32 v46, v46
    v_exp_f32 v47, v47
    v_exp_f32 v48, v48
    v_exp_f32 v49, v49
    v_smfmac_f32_32x32x32_bf16 v[72:87], v[16:19], v[40:47], v3
    ds_read_b128 v[16:19], v2 offset:2048
    v_exp_f32 v50, v50
    v_exp_f32 v51, v51
    v_exp_f32 v52, v52
    v_exp_f32 v53, v53
    v_exp_f32 v54, v54
    v_exp_f32 v55, v55
    v_exp_f32 v24, v24
    v_exp_f32 v25, v25
    s_waitcnt lgkmcnt(0)
    v_smfmac_f32_32x32x32_bf16 v[72:87], v[20:23], v[48:55], v3
    ds_read_b128 v[20:23], v2 offset:2560
    v_exp_f32 v26, v26
    v_exp_f32 v27, v27
    v_exp_f32 v28, v28
    v_mfma_f32_32x32x16_bf16 v[40:55], v[12:15], v[8:11], v[56:71]
    ds_read_b128 v[12:15], v1 offset:4096
    v_exp_f32 v29, v29
    v_exp_f32 v30, v30
    v_exp_f32 v31, v31
    v_exp_f32 v32, v32
    v_exp_f32 v33, v33
    v_smfmac_f32_32x32x32_bf16 v[72:87], v[16:19], v[24:31], v3
    ds_read_b128 v[16:19], v2 offset:3072
    v_exp_f32 v34, v34
    v_exp_f32 v35, v35
    v_exp_f32 v36, v36
    v_exp_f32 v37, v37
    v_exp_f32 v38, v38
    v_exp_f32 v39, v39
    v_exp_f32 v40, v40
    v_exp_f32 v41, v41
    s_waitcnt lgkmcnt(0)
    v_smfmac_f32_32x32x32_bf16 v[72:87], v[20:23], v[32:39], v3
    ds_read_b128 v[20:23], v2 offset:3584
    v_exp_f32 v42, v42
    v_exp_f32 v43, v43
    v_exp_f32 v44, v44
    v_mfma_f32_32x32x16_bf16 v[24:39], v[12:15], v[8:11], v[56:71]
    ds_read_b128 v[12:15], v1 offset:5120
    v_exp_f32 v45, v45
    v_exp_f32 v46, v46
    v_exp_f32 v47, v47
    v_exp_f32 v48, v48
    v_exp_f32 v49, v49
    v_smfmac_f32_32x32x32_bf16 v[72:87], v[16:19], v[40:47], v3
    ds_read_b128 v[16:19], v2 offset:4096
    v_exp_f32 v50, v50
    v_exp_f32 v51, v51
    v_exp_f32 v52, v52
    v_exp_f32 v53, v53
    v_exp_f32 v54, v54
    v_exp_f32 v55, v55
    v_exp_f32 v24, v24
    v_exp_f32 v25, v25
    s_waitcnt lgkmcnt(0)
    v_smfmac_f32_32x32x32_bf16 v[72:87], v[20:23], v[48:55], v3
    ds_read_b128 v[20:23], v2 offset:4608
    v_exp_f32 v26, v26
    v_exp_f32 v27, v27
    v_exp_f32 v28, v28
    v_mfma_f32_32x32x16_bf16 v[40:55], v[12:15], v[8:11], v[56:71]
    ds_read_b128 v[12:15], v1 offset:6144
    v_exp_f32 v29, v29
    v_exp_f32 v30, v30
    v_exp_f32 v31, v31
    v_exp_f32 v32, v32
    v_exp_f32 v33, v33
    v_smfmac_f32_32x32x32_bf16 v[72:87], v[16:19], v[24:31], v3
    ds_read_b128 v[16:19], v2 offset:5120
    v_exp_f32 v34, v34
    v_exp_f32 v35, v35
    v_exp_f32 v36, v36
    v_exp_f32 v37, v37
    v_exp_f32 v38, v38
    v_exp_f32 v39, v39
    v_exp_f32 v40, v40
    v_exp_f32 v41, v41
    s_waitcnt lgkmcnt(0)
    v_smfmac_f32_32x32x32_bf16 v[72:87], v[20:23], v[32:39], v3
    ds_read_b128 v[20:23], v2 offset:5632
    v_exp_f32 v42, v42
    v_exp_f32 v43, v43
    v_exp_f32 v44, v44
    v_mfma_f32_32x32x16_bf16 v[24:39], v[12:15], v[8:11], v[56:71]
    ds_read_b128 v[12:15], v1 offset:7168
    v_exp_f32 v45, v45
    v_exp_f32 v46, v46
    v_exp_f32 v47, v47
    v_exp_f32 v48, v48
    v_exp_f32 v49, v49
    v_smfmac_f32_32x32x32_bf16 v[72:87], v[16:19], v[40:47], v3
    ds_read_b128 v[16:19], v2 offset:6144
    v_exp_f32 v50, v50
    v_exp_f32 v51, v51
    v_exp_f32 v52, v52
    v_exp_f32 v53, v53
    v_exp_f32 v54, v54
    v_exp_f32 v55, v55
    v_exp_f32 v24, v24
    v_exp_f32 v25, v25
    s_waitcnt lgkmcnt(0)
    v_smfmac_f32_32x32x32_bf16 v[72:87], v[20:23], v[48:55], v3
    ds_read_b128 v[20:23], v2 offset:6656
    v_exp_f32 v26, v26
    v_exp_f32 v27, v27
    v_exp_f32 v28, v28
    v_mfma_f32_32x32x16_bf16 v[40:55], v[12:15], v[8:11], v[56:71]
    ds_read_b128 v[12:15], v1 offset:8192
    v_exp_f32 v29, v29
    v_exp_f32 v30, v30
    v_exp_f32 v31, v31
    v_exp_f32 v32, v32
    v_exp_f32 v33, v33
    v_smfmac_f32_32x32x32_bf16 v[72:87], v[16:19], v[24:31], v3
    ds_read_b128 v[16:19], v2 offset:7168
    v_exp_f32 v34, v34
    v_exp_f32 v35, v35
    v_exp_f32 v36, v36
    v_exp_f32 v37, v37
    v_exp_f32 v38, v38
    v_exp_f32 v39, v39
    v_exp_f32 v40, v40
    v_exp_f32 v41, v41
    s_waitcnt lgkmcnt(0)
    v_smfmac_f32_32x32x32_bf16 v[72:87], v[20:23], v[32:39], v3
    ds_read_b128 v[20:23], v2 offset:7680
    v_exp_f32 v42, v42
    v_exp_f32 v43, v43
    v_exp_f32 v44, v44
    v_mfma_f32_32x32x16_bf16 v[24:39], v[12:15], v[8:11], v[56:71]
    ds_read_b128 v[12:15], v1 offset:9216
    v_exp_f32 v45, v45
    v_exp_f32 v46, v46
    v_exp_f32 v47, v47
    v_exp_f32 v48, v48
    v_exp_f32 v49, v49
    v_smfmac_f32_32x32x32_bf16 v[72:87], v[16:19], v[40:47], v3
    ds_read_b128 v[16:19], v2 offset:8192
    v_exp_f32 v50, v50
    v_exp_f32 v51, v51
    v_exp_f32 v52, v52
    v_exp_f32 v53, v53
    v_exp_f32 v54, v54
    v_exp_f32 v55, v55
    v_add_u32 v1, 0x2000, v1
    v_add_u32 v2, v4, v2
    s_sub_u32 s66, s66, 1
    s_cmp_lg_u32 s66, 0
    s_cbranch_scc1 F_loop
    s_branch F_attn_done
.section .rodata,"a"
.p2align 6
.amdhsa_kernel concat_heads__spectral_fnet__softmax_full_mha__prompt_kernel
  .amdhsa_next_free_vgpr 224
  .amdhsa_next_free_sgpr 102
  .amdhsa_accum_offset 224
  .amdhsa_group_segment_fixed_size 0
  .amdhsa_kernarg_size 88
  .amdhsa_user_sgpr_count 2
  .amdhsa_user_sgpr_kernarg_segment_ptr 1
  .amdhsa_system_sgpr_workgroup_id_x 1
  .amdhsa_float_denorm_mode_32 3
.end_amdhsa_kernel
```
